```python
import torch

def _softmax(x, axis=-1):
    return torch.softmax(x, dim=axis)
def _gelu(x):
    return torch.nn.functional.gelu(x, approximate="tanh")
def _silu(x):
    return torch.nn.functional.silu(x)
def _sigmoid(x):
    return torch.sigmoid(x)
def _layernorm(x, axis=-1, eps=1e-5):
    m = x.mean(dim=axis, keepdim=True)
    v = x.var(dim=axis, keepdim=True, unbiased=False)
    return (x - m) / torch.sqrt(v + eps)
def _scatter_add(tgt, idx, src, axis=0):
    return tgt.clone().index_add_(axis, idx, src)
def _segment_sum(src, seg, n):
    out = torch.zeros((n,) + src.shape[1:], dtype=src.dtype)
    return out.index_add_(0, seg, src)
def _pad(x, pw):
    flat = tuple(v for pair in reversed(pw) for v in pair)
    return torch.nn.functional.pad(x, flat)

kernel_name = 'gated_mix__compressed_kv_cla__geglu_ffn__decode'

def setup_inputs():

    _w = (lambda a: (lambda t: t.to(torch.bfloat16) if t.is_floating_point() else t)(torch.as_tensor(a)))
    def _A_setup():
        B, H, Sq, Sk, D, M = 2, 32, 1, 8192, 128, 512
        Dc = 4 * D
        return {
            "x": _w((lambda *s: torch.randn(*s, dtype=torch.bfloat16) * 0.05)(B, Sq, M)),
            "c_kv": _w((lambda *s: torch.randn(*s, dtype=torch.bfloat16) * 1.6)(B, Sk, Dc)),
            "w_q": _w((lambda *s: torch.randn(*s, dtype=torch.bfloat16) * 6.4)(M, H, D) * (M ** -0.5)),
            "w_uk": _w((lambda *s: torch.randn(*s, dtype=torch.bfloat16) * 6.4)(Dc, H, D) * (Dc ** -0.5)),
            "w_uv": _w((lambda *s: torch.randn(*s, dtype=torch.bfloat16) * 1.6)(Dc, H, D) * (Dc ** -0.5)),
            "w_o": _w((lambda *s: torch.randn(*s, dtype=torch.bfloat16) * 1.6)(H, D, M) * ((H * D) ** -0.5)),
        }
    _A_in = _A_setup()

    def _B_setup():
        B, S, D, F = 2, 1, 512, 1792
        return {
            "x": _w((lambda *s: torch.randn(*s, dtype=torch.bfloat16) * 0.05)(B, S, D)),
            "w_gate": _w((lambda *s: torch.randn(*s, dtype=torch.bfloat16) * 0.4)(D, F)),
            "w_up": _w((lambda *s: torch.randn(*s, dtype=torch.bfloat16) * 0.4)(D, F)),
            "w_down": _w((lambda *s: torch.randn(*s, dtype=torch.bfloat16) * 0.4)(F, D)),
        }
    _B_in = _B_setup()

    return {
        "A_x": _A_in["x"],
        "A_c_kv": _A_in["c_kv"],
        "A_w_q": _A_in["w_q"],
        "A_w_uk": _A_in["w_uk"],
        "A_w_uv": _A_in["w_uv"],
        "A_w_o": _A_in["w_o"],
        "B_x": _B_in["x"],
        "B_w_gate": _B_in["w_gate"],
        "B_w_up": _B_in["w_up"],
        "B_w_down": _B_in["w_down"],
        "gate_w": _w((lambda *s: torch.randn(*s, dtype=torch.bfloat16) * 0.1)(512) * 16.0),
    }

def reference(A_x, A_c_kv, A_w_q, A_w_uk, A_w_uv, A_w_o, B_x, B_w_gate, B_w_up, B_w_down, gate_w):
    def _A_ref(x, c_kv, w_q, w_uk, w_uv, w_o):
        B, Sq, M = x.shape[0], x.shape[1], x.shape[2]
        Sk = c_kv.shape[1]
        H, D = w_q.shape[1], w_q.shape[2]
        q = torch.einsum("bqm,mhd->bhqd", x, w_q)
        k = torch.einsum("bkc,chd->bhkd", c_kv, w_uk)
        v = torch.einsum("bkc,chd->bhkd", c_kv, w_uv)
        scores = torch.einsum("bhqd,bhkd->bhqk", q, k) * (D ** -0.5)
        off = Sk - Sq
        qi = torch.arange(Sq)[:, None]
        kj = torch.arange(Sk)[None, :]
        cmask = kj <= (qi + off)
        scores = torch.where(cmask[None, None], scores, -1e9)
        p = _softmax(scores, axis=-1)
        ctx = torch.einsum("bhqk,bhkd->bhqd", p, v)
        return torch.einsum("bhqd,hdm->bqm", ctx, w_o)

    def _B_ref(x, w_gate, w_up, w_down):
        return (_gelu(x @ w_gate) * (x @ w_up)) @ w_down

    x = A_x
    g = _sigmoid((x * gate_w).sum(-1, keepdims=True))
    a = _A_ref(x, A_c_kv, A_w_q, A_w_uk, A_w_uv, A_w_o)
    b = _B_ref(x, B_w_gate, B_w_up, B_w_down)
    return g * a + (1 - g) * b
```

```asm
; @launch grid=(256,1,1) block=(256,1,1) lds=163840
.amdgcn_target "amdgcn-amd-amdhsa--gfx950"
.text
.globl gated_mix__compressed_kv_cla__geglu_ffn__decode_kernel
.p2align 8
.type gated_mix__compressed_kv_cla__geglu_ffn__decode_kernel,@function
gated_mix__compressed_kv_cla__geglu_ffn__decode_kernel:
    s_cmp_ge_u32 s2, 256
    s_cbranch_scc1 L_EXIT
    s_load_dwordx4 s[4:7], s[0:1], 0
    s_load_dwordx4 s[8:11], s[0:1], 16
    s_load_dwordx4 s[12:15], s[0:1], 32
    s_load_dwordx4 s[36:39], s[0:1], 56
    s_load_dwordx4 s[40:43], s[0:1], 72
    s_load_dwordx4 s[44:47], s[0:1], 88
    s_load_dwordx2 s[16:17], s[0:1], 104
    s_memrealtime s[48:49]
    s_mov_b32 s35, 200000
    v_and_b32 v1, 63, v0
    v_lshrrev_b32 v5, 6, v0
    v_and_b32 v2, 15, v1
    v_lshrrev_b32 v3, 4, v1
    v_readfirstlane_b32 s18, v5
    s_and_b32 s21, s2, 7
    s_lshr_b32 s22, s2, 3
    s_lshr_b32 s23, s22, 3
    s_lshl_b32 s23, s23, 3
    s_add_u32 s19, s21, s23
    s_and_b32 s20, s22, 7
    v_and_b32 v6, 7, v2
    v_mov_b32 v16, 0x0c0c0c0c
    v_mov_b32 v7, 0x0c0c0100
    v_cmp_eq_u32 vcc, 0, v6
    s_nop 1
    v_cndmask_b32 v16, v16, v7, vcc
    v_mov_b32 v7, 0x01000c0c
    v_cmp_eq_u32 vcc, 1, v6
    s_nop 1
    v_cndmask_b32 v16, v16, v7, vcc

    v_mov_b32 v17, 0x0c0c0c0c
    v_mov_b32 v7, 0x0c0c0302
    v_cmp_eq_u32 vcc, 0, v6
    s_nop 1
    v_cndmask_b32 v17, v17, v7, vcc
    v_mov_b32 v7, 0x03020c0c
    v_cmp_eq_u32 vcc, 1, v6
    s_nop 1
    v_cndmask_b32 v17, v17, v7, vcc

    v_mov_b32 v18, 0x0c0c0c0c
    v_mov_b32 v7, 0x0c0c0100
    v_cmp_eq_u32 vcc, 2, v6
    s_nop 1
    v_cndmask_b32 v18, v18, v7, vcc
    v_mov_b32 v7, 0x01000c0c
    v_cmp_eq_u32 vcc, 3, v6
    s_nop 1
    v_cndmask_b32 v18, v18, v7, vcc

    v_mov_b32 v19, 0x0c0c0c0c
    v_mov_b32 v7, 0x0c0c0302
    v_cmp_eq_u32 vcc, 2, v6
    s_nop 1
    v_cndmask_b32 v19, v19, v7, vcc
    v_mov_b32 v7, 0x03020c0c
    v_cmp_eq_u32 vcc, 3, v6
    s_nop 1
    v_cndmask_b32 v19, v19, v7, vcc

    v_mov_b32 v20, 0x0c0c0c0c
    v_mov_b32 v7, 0x0c0c0100
    v_cmp_eq_u32 vcc, 4, v6
    s_nop 1
    v_cndmask_b32 v20, v20, v7, vcc
    v_mov_b32 v7, 0x01000c0c
    v_cmp_eq_u32 vcc, 5, v6
    s_nop 1
    v_cndmask_b32 v20, v20, v7, vcc

    v_mov_b32 v21, 0x0c0c0c0c
    v_mov_b32 v7, 0x0c0c0302
    v_cmp_eq_u32 vcc, 4, v6
    s_nop 1
    v_cndmask_b32 v21, v21, v7, vcc
    v_mov_b32 v7, 0x03020c0c
    v_cmp_eq_u32 vcc, 5, v6
    s_nop 1
    v_cndmask_b32 v21, v21, v7, vcc

    v_mov_b32 v22, 0x0c0c0c0c
    v_mov_b32 v7, 0x0c0c0100
    v_cmp_eq_u32 vcc, 6, v6
    s_nop 1
    v_cndmask_b32 v22, v22, v7, vcc
    v_mov_b32 v7, 0x01000c0c
    v_cmp_eq_u32 vcc, 7, v6
    s_nop 1
    v_cndmask_b32 v22, v22, v7, vcc

    v_mov_b32 v23, 0x0c0c0c0c
    v_mov_b32 v7, 0x0c0c0302
    v_cmp_eq_u32 vcc, 6, v6
    s_nop 1
    v_cndmask_b32 v23, v23, v7, vcc
    v_mov_b32 v7, 0x03020c0c
    v_cmp_eq_u32 vcc, 7, v6
    s_nop 1
    v_cndmask_b32 v23, v23, v7, vcc

    s_waitcnt lgkmcnt(0)
    s_or_b32 s48, s48, 1
    s_cmp_eq_u32 s2, 0
    s_cbranch_scc0 L_NONONCE
    s_cmp_eq_u32 s18, 0
    s_cbranch_scc0 L_NONONCE
    v_mov_b32 v6, 0
    v_mov_b32 v7, s48
    s_mov_b64 s[22:23], exec
    s_mov_b64 exec, 1
    global_store_dword v6, v7, s[46:47] sc0 sc1
    s_mov_b64 exec, s[22:23]
L_NONONCE:
    v_lshrrev_b32 v6, 3, v2
    v_lshlrev_b32 v6, 10, v6
    v_lshl_add_u32 v6, v3, 3, v6
    s_lshl_b32 s22, s18, 5
    v_add_u32 v15, s22, v6
    s_lshl_b32 s21, s20, 7
    v_add_u32 v7, s21, v15
    global_load_dwordx2 v[40:41], v7, s[4:5]
    s_lshl_b32 s21, s20, 6
    s_lshl_b32 s22, s18, 4
    s_add_u32 s21, s21, s22
    v_lshl_add_u32 v6, v3, 2, s21
    v_lshlrev_b32 v7, 13, v6
    v_lshl_add_u32 v7, v2, 4, v7
    s_lshl_b32 s22, s19, 8
    v_add_u32 v7, s22, v7
    s_mov_b32 s24, s8
    s_mov_b32 s25, s9
    global_load_dwordx4 v[48:51], v7, s[24:25] nt
    s_add_u32 s24, s24, 8192
    s_addc_u32 s25, s25, 0
    global_load_dwordx4 v[52:55], v7, s[24:25] nt
    s_add_u32 s24, s24, 8192
    s_addc_u32 s25, s25, 0
    global_load_dwordx4 v[56:59], v7, s[24:25] nt
    s_add_u32 s24, s24, 8192
    s_addc_u32 s25, s25, 0
    global_load_dwordx4 v[60:63], v7, s[24:25] nt
    s_sleep 10
    v_mov_b32 v6, 0
    global_load_dword v44, v6, s[46:47] sc0 sc1
    s_lshl_b32 s21, s20, 6
    s_lshl_b32 s22, s18, 4
    s_add_u32 s21, s21, s22
    v_add_u32 v5, s21, v2
    v_lshlrev_b32 v5, 13, v5
    v_lshl_add_u32 v5, v3, 4, v5
    s_lshl_b32 s22, s19, 8
    v_add_u32 v5, s22, v5
    global_load_dwordx4 v[80:83], v5, s[10:11] offset:0 nt
    global_load_dwordx4 v[84:87], v5, s[10:11] offset:64 nt
    global_load_dwordx4 v[88:91], v5, s[10:11] offset:128 nt
    global_load_dwordx4 v[92:95], v5, s[10:11] offset:192 nt
    v_lshlrev_b32 v6, 4, v1
    global_load_dwordx4 v[100:103], v6, s[4:5]
    global_load_dwordx4 v[104:107], v6, s[4:5] offset:1024
    global_load_dwordx4 v[108:111], v6, s[42:43]
    s_mul_hi_u32 s27, s2, 153391690
    s_mul_i32 s21, s27, 28
    s_sub_u32 s26, s2, s21
    s_min_u32 s27, s27, 7
    s_and_b32 s21, s2, 7
    s_lshr_b32 s22, s2, 3
    s_and_b32 s28, s22, 1
    s_lshr_b32 s22, s22, 1
    s_lshl_b32 s21, s21, 4
    s_add_u32 s29, s21, s22
    s_lshr_b32 s30, s29, 6
    s_and_b32 s31, s29, 63
    v_mov_b32 v32, 0
    v_mov_b32 v33, 0
    v_mov_b32 v34, 0
    v_mov_b32 v35, 0
    s_waitcnt vmcnt(8)
    v_perm_b32 v24, v40, v40, v16
    v_perm_b32 v25, v40, v40, v18
    v_perm_b32 v26, v40, v40, v20
    v_perm_b32 v27, v40, v40, v22
    s_nop 1
    v_mfma_f32_16x16x32_bf16 v[32:35], v[48:51], v[24:27], v[32:35]
    v_perm_b32 v28, v40, v40, v17
    v_perm_b32 v29, v40, v40, v19
    v_perm_b32 v30, v40, v40, v21
    v_perm_b32 v31, v40, v40, v23
    s_nop 1
    v_mfma_f32_16x16x32_bf16 v[32:35], v[52:55], v[28:31], v[32:35]
    v_perm_b32 v24, v41, v41, v16
    v_perm_b32 v25, v41, v41, v18
    v_perm_b32 v26, v41, v41, v20
    v_perm_b32 v27, v41, v41, v22
    s_nop 1
    v_mfma_f32_16x16x32_bf16 v[32:35], v[56:59], v[24:27], v[32:35]
    v_perm_b32 v28, v41, v41, v17
    v_perm_b32 v29, v41, v41, v19
    v_perm_b32 v30, v41, v41, v21
    v_perm_b32 v31, v41, v41, v23
    s_nop 1
    v_mfma_f32_16x16x32_bf16 v[32:35], v[60:63], v[28:31], v[32:35]
    s_nop 7
    v_lshlrev_b32 v6, 4, v1
    s_lshl_b32 s21, s18, 10
    s_add_u32 s21, s21, 131072
    v_add_u32 v6, s21, v6
    ds_write_b128 v6, v[32:35]
    s_waitcnt lgkmcnt(0)
    s_barrier
    v_lshlrev_b32 v6, 2, v0
    v_add_u32 v6, 131072, v6
    ds_read2st64_b32 v[48:49], v6 offset0:0 offset1:4
    ds_read2st64_b32 v[50:51], v6 offset0:8 offset1:12
    s_waitcnt vmcnt(7)
L_NONCE_CHK:
    v_readfirstlane_b32 s34, v44
    s_cmp_lg_u32 s34, 0
    s_cbranch_scc1 L_NONCE_OK
    s_sub_u32 s35, s35, 1
    s_cbranch_scc1 L_EXIT
    s_sleep 4
    v_mov_b32 v6, 0
    global_load_dword v44, v6, s[46:47] sc0 sc1
    s_waitcnt vmcnt(0)
    s_branch L_NONCE_CHK
L_NONCE_OK:
    s_waitcnt lgkmcnt(0)
    v_add_f32 v48, v48, v49
    v_add_f32 v50, v50, v51
    v_add_f32 v48, v48, v50
    v_mov_b32 v49, s34
    s_lshl_b32 s21, s19, 3
    s_add_u32 s21, s21, s20
    s_lshl_b32 s21, s21, 11
    s_add_u32 s21, s21, 0x0
    v_lshl_add_u32 v6, v0, 3, s21
    global_store_dwordx2 v6, v[48:49], s[16:17] sc0 sc1
    s_lshl_b32 s24, s29, 17
    s_lshl_b32 s25, s18, 8
    s_add_u32 s24, s24, s25
    v_lshlrev_b32 v6, 1, v3
    v_xor_b32 v7, v6, v2
    v_xor_b32 v8, 8, v7
    v_lshlrev_b32 v9, 10, v3
    v_lshl_add_u32 v12, v7, 4, v9
    v_lshl_add_u32 v13, v8, 4, v9
    v_add_u32 v12, s24, v12
    v_add_u32 v13, s24, v13
    s_mov_b32 s24, s6
    s_mov_b32 s25, s7
    s_lshl_b32 s33, s18, 15
    s_add_u32 m0, s33, 0
    s_nop 0
    global_load_lds_dwordx4 v12, s[24:25] nt
    s_add_u32 s24, s24, 4096
    s_addc_u32 s25, s25, 0
    s_add_u32 m0, s33, 1024
    s_nop 0
    global_load_lds_dwordx4 v13, s[24:25] nt
    s_add_u32 s24, s24, 4096
    s_addc_u32 s25, s25, 0
    s_add_u32 m0, s33, 2048
    s_nop 0
    global_load_lds_dwordx4 v12, s[24:25] nt
    s_add_u32 s24, s24, 4096
    s_addc_u32 s25, s25, 0
    s_add_u32 m0, s33, 3072
    s_nop 0
    global_load_lds_dwordx4 v13, s[24:25] nt
    s_add_u32 s24, s24, 4096
    s_addc_u32 s25, s25, 0
    s_add_u32 m0, s33, 4096
    s_nop 0
    global_load_lds_dwordx4 v12, s[24:25] nt
    s_add_u32 s24, s24, 4096
    s_addc_u32 s25, s25, 0
    s_add_u32 m0, s33, 5120
    s_nop 0
    global_load_lds_dwordx4 v13, s[24:25] nt
    s_add_u32 s24, s24, 4096
    s_addc_u32 s25, s25, 0
    s_add_u32 m0, s33, 6144
    s_nop 0
    global_load_lds_dwordx4 v12, s[24:25] nt
    s_add_u32 s24, s24, 4096
    s_addc_u32 s25, s25, 0
    s_add_u32 m0, s33, 7168
    s_nop 0
    global_load_lds_dwordx4 v13, s[24:25] nt
    s_add_u32 s24, s24, 4096
    s_addc_u32 s25, s25, 0
    s_add_u32 m0, s33, 8192
    s_nop 0
    global_load_lds_dwordx4 v12, s[24:25] nt
    s_add_u32 s24, s24, 4096
    s_addc_u32 s25, s25, 0
    s_add_u32 m0, s33, 9216
    s_nop 0
    global_load_lds_dwordx4 v13, s[24:25] nt
    s_add_u32 s24, s24, 4096
    s_addc_u32 s25, s25, 0
    s_add_u32 m0, s33, 10240
    s_nop 0
    global_load_lds_dwordx4 v12, s[24:25] nt
    s_add_u32 s24, s24, 4096
    s_addc_u32 s25, s25, 0
    s_add_u32 m0, s33, 11264
    s_nop 0
    global_load_lds_dwordx4 v13, s[24:25] nt
    s_add_u32 s24, s24, 4096
    s_addc_u32 s25, s25, 0
    s_add_u32 m0, s33, 12288
    s_nop 0
    global_load_lds_dwordx4 v12, s[24:25] nt
    s_add_u32 s24, s24, 4096
    s_addc_u32 s25, s25, 0
    s_add_u32 m0, s33, 13312
    s_nop 0
    global_load_lds_dwordx4 v13, s[24:25] nt
    s_add_u32 s24, s24, 4096
    s_addc_u32 s25, s25, 0
    s_add_u32 m0, s33, 14336
    s_nop 0
    global_load_lds_dwordx4 v12, s[24:25] nt
    s_add_u32 s24, s24, 4096
    s_addc_u32 s25, s25, 0
    s_add_u32 m0, s33, 15360
    s_nop 0
    global_load_lds_dwordx4 v13, s[24:25] nt
    s_add_u32 s24, s24, 4096
    s_addc_u32 s25, s25, 0
    s_lshl_b32 s21, s19, 14
    s_add_u32 s21, s21, 0x0
    v_lshl_add_u32 v10, v0, 3, s21
    v_add_u32 v11, 4096, v10
    v_add_u32 v14, 8192, v10
    v_add_u32 v9, 12288, v10
    global_load_dwordx2 v[48:49], v10, s[16:17] offset:0 sc0 sc1
    global_load_dwordx2 v[50:51], v10, s[16:17] offset:2048 sc0 sc1
    global_load_dwordx2 v[52:53], v11, s[16:17] offset:0 sc0 sc1
    global_load_dwordx2 v[54:55], v11, s[16:17] offset:2048 sc0 sc1
    global_load_dwordx2 v[56:57], v14, s[16:17] offset:0 sc0 sc1
    global_load_dwordx2 v[58:59], v14, s[16:17] offset:2048 sc0 sc1
    global_load_dwordx2 v[60:61], v9, s[16:17] offset:0 sc0 sc1
    global_load_dwordx2 v[62:63], v9, s[16:17] offset:2048 sc0 sc1
    s_add_u32 m0, s33, 16384
    s_nop 0
    global_load_lds_dwordx4 v12, s[24:25] nt
    s_add_u32 s24, s24, 4096
    s_addc_u32 s25, s25, 0
    s_add_u32 m0, s33, 17408
    s_nop 0
    global_load_lds_dwordx4 v13, s[24:25] nt
    s_add_u32 s24, s24, 4096
    s_addc_u32 s25, s25, 0
    s_add_u32 m0, s33, 18432
    s_nop 0
    global_load_lds_dwordx4 v12, s[24:25] nt
    s_add_u32 s24, s24, 4096
    s_addc_u32 s25, s25, 0
    s_add_u32 m0, s33, 19456
    s_nop 0
    global_load_lds_dwordx4 v13, s[24:25] nt
    s_add_u32 s24, s24, 4096
    s_addc_u32 s25, s25, 0
    s_add_u32 m0, s33, 20480
    s_nop 0
    global_load_lds_dwordx4 v12, s[24:25] nt
    s_add_u32 s24, s24, 4096
    s_addc_u32 s25, s25, 0
    s_add_u32 m0, s33, 21504
    s_nop 0
    global_load_lds_dwordx4 v13, s[24:25] nt
    s_add_u32 s24, s24, 4096
    s_addc_u32 s25, s25, 0
    s_add_u32 m0, s33, 22528
    s_nop 0
    global_load_lds_dwordx4 v12, s[24:25] nt
    s_add_u32 s24, s24, 4096
    s_addc_u32 s25, s25, 0
    s_add_u32 m0, s33, 23552
    s_nop 0
    global_load_lds_dwordx4 v13, s[24:25] nt
    s_add_u32 s24, s24, 4096
    s_addc_u32 s25, s25, 0
    s_add_u32 m0, s33, 24576
    s_nop 0
    global_load_lds_dwordx4 v12, s[24:25] nt
    s_add_u32 s24, s24, 4096
    s_addc_u32 s25, s25, 0
    s_add_u32 m0, s33, 25600
    s_nop 0
    global_load_lds_dwordx4 v13, s[24:25] nt
    s_add_u32 s24, s24, 4096
    s_addc_u32 s25, s25, 0
    s_add_u32 m0, s33, 26624
    s_nop 0
    global_load_lds_dwordx4 v12, s[24:25] nt
    s_add_u32 s24, s24, 4096
    s_addc_u32 s25, s25, 0
    s_add_u32 m0, s33, 27648
    s_nop 0
    global_load_lds_dwordx4 v13, s[24:25] nt
    s_add_u32 s24, s24, 4096
    s_addc_u32 s25, s25, 0
    s_add_u32 m0, s33, 28672
    s_nop 0
    global_load_lds_dwordx4 v12, s[24:25] nt
    s_add_u32 s24, s24, 4096
    s_addc_u32 s25, s25, 0
    s_add_u32 m0, s33, 29696
    s_nop 0
    global_load_lds_dwordx4 v13, s[24:25] nt
    s_add_u32 s24, s24, 4096
    s_addc_u32 s25, s25, 0
    s_add_u32 m0, s33, 30720
    s_nop 0
    global_load_lds_dwordx4 v12, s[24:25] nt
    s_add_u32 s24, s24, 4096
    s_addc_u32 s25, s25, 0
    s_add_u32 m0, s33, 31744
    s_nop 0
    global_load_lds_dwordx4 v13, s[24:25] nt
    s_lshl_b32 s21, s27, 7
    v_add_u32 v7, s21, v15
    global_load_dwordx2 v[42:43], v7, s[4:5]
    s_lshl_b32 s21, s27, 6
    s_lshl_b32 s22, s18, 4
    s_add_u32 s21, s21, s22
    v_lshl_add_u32 v6, v3, 2, s21
    s_movk_i32 s22, 3584
    v_mul_lo_u32 v6, v6, s22
    v_and_b32 v7, 7, v2
    v_lshl_add_u32 v6, v7, 4, v6
    s_lshl_b32 s21, s26, 7
    v_add_u32 v6, s21, v6
    v_cmp_gt_u32 vcc, 8, v2
    v_mov_b32 v8, s38
    v_mov_b32 v5, s36
    v_cndmask_b32 v8, v8, v5, vcc
    v_mov_b32 v7, s39
    v_mov_b32 v5, s37
    v_cndmask_b32 v7, v7, v5, vcc
    v_add_co_u32 v6, vcc, v8, v6
    s_nop 1
    v_addc_co_u32 v7, vcc, 0, v7, vcc
    global_load_dwordx4 v[64:67], v[6:7], off nt
    global_load_dwordx4 v[68:71], v[6:7], off offset:3584 nt
    v_add_co_u32 v6, vcc, 7168, v6
    s_nop 1
    v_addc_co_u32 v7, vcc, 0, v7, vcc
    global_load_dwordx4 v[72:75], v[6:7], off nt
    global_load_dwordx4 v[76:79], v[6:7], off offset:3584 nt
    s_waitcnt vmcnt(21)
L_E1_CHK:
    v_xor_b32 v4, s34, v49
    v_xor_b32 v5, s34, v51
    v_or_b32 v4, v4, v5
    v_xor_b32 v5, s34, v53
    v_or_b32 v4, v4, v5
    v_xor_b32 v5, s34, v55
    v_or_b32 v4, v4, v5
    v_xor_b32 v5, s34, v57
    v_or_b32 v4, v4, v5
    v_xor_b32 v5, s34, v59
    v_or_b32 v4, v4, v5
    v_xor_b32 v5, s34, v61
    v_or_b32 v4, v4, v5
    v_xor_b32 v5, s34, v63
    v_or_b32 v4, v4, v5
    v_cmp_ne_u32 vcc, 0, v4
    s_cbranch_vccz L_E1_OK
    s_sub_u32 s35, s35, 1
    s_cbranch_scc1 L_EXIT
    s_sleep 1

    global_load_dwordx2 v[48:49], v10, s[16:17] offset:0 sc0 sc1
    global_load_dwordx2 v[50:51], v10, s[16:17] offset:2048 sc0 sc1
    global_load_dwordx2 v[52:53], v11, s[16:17] offset:0 sc0 sc1
    global_load_dwordx2 v[54:55], v11, s[16:17] offset:2048 sc0 sc1
    global_load_dwordx2 v[56:57], v14, s[16:17] offset:0 sc0 sc1
    global_load_dwordx2 v[58:59], v14, s[16:17] offset:2048 sc0 sc1
    global_load_dwordx2 v[60:61], v9, s[16:17] offset:0 sc0 sc1
    global_load_dwordx2 v[62:63], v9, s[16:17] offset:2048 sc0 sc1
    s_waitcnt vmcnt(0)
    s_branch L_E1_CHK
L_E1_OK:
    v_lshrrev_b32 v7, 2, v0
    v_and_b32 v8, 3, v0
    v_lshrrev_b32 v9, 4, v7
    v_lshl_add_u32 v8, v9, 2, v8
    v_and_b32 v9, 15, v7
    v_lshrrev_b32 v10, 3, v9
    v_and_b32 v11, 7, v9
    v_add_f32 v48, v48, v50
    v_add_f32 v52, v52, v54
    v_add_f32 v56, v56, v58
    v_add_f32 v60, v60, v62
    v_add_f32 v48, v48, v52
    v_add_f32 v56, v56, v60
    v_add_f32 v48, v48, v56
    v_lshl_add_u32 v49, v8, 3, v11
    v_lshl_add_u32 v49, v10, 7, v49
    v_lshlrev_b32 v49, 1, v49
    v_add_u32 v49, 131072, v49
    v_cvt_pk_bf16_f32 v48, v48, v48
    ds_write_b16 v49, v48 offset:8192
    s_waitcnt lgkmcnt(0)
    s_barrier
    v_and_b32 v6, 1, v2
    v_lshlrev_b32 v6, 8, v6
    v_lshl_add_u32 v6, v3, 4, v6
    v_add_u32 v6, 131072, v6
    ds_read_b128 v[48:51], v6 offset:8192
    ds_read_b128 v[52:55], v6 offset:8256
    ds_read_b128 v[56:59], v6 offset:8320
    ds_read_b128 v[60:63], v6 offset:8384
    v_mov_b32 v32, 0
    v_mov_b32 v33, 0
    v_mov_b32 v34, 0
    v_mov_b32 v35, 0
    s_waitcnt lgkmcnt(0)
    v_mfma_f32_16x16x32_bf16 v[32:35], v[80:83], v[48:51], v[32:35]
    v_mfma_f32_16x16x32_bf16 v[32:35], v[84:87], v[52:55], v[32:35]
    v_mfma_f32_16x16x32_bf16 v[32:35], v[88:91], v[56:59], v[32:35]
    v_mfma_f32_16x16x32_bf16 v[32:35], v[92:95], v[60:63], v[32:35]
    s_nop 7
    s_mov_b32 s21, 0x3e0293ee
    v_mul_f32 v32, s21, v32
    v_mul_f32 v33, s21, v33
    v_mul_f32 v34, s21, v34
    v_mul_f32 v35, s21, v35
    v_cvt_pk_bf16_f32 v32, v32, v33
    v_cvt_pk_bf16_f32 v34, v34, v35
    v_mov_b32 v33, s34
    v_mov_b32 v35, s34
    v_lshlrev_b32 v6, 5, v2
    v_add_u32 v6, s19, v6
    v_lshlrev_b32 v6, 8, v6
    v_lshl_add_u32 v6, v3, 1, v6
    s_lshl_b32 s21, s20, 5
    s_lshl_b32 s22, s18, 3
    s_add_u32 s21, s21, s22
    v_add_u32 v6, s21, v6
    v_lshlrev_b32 v6, 3, v6
    v_add_u32 v6, 0x100000, v6
    v_cmp_gt_u32 vcc, 2, v2
    s_and_saveexec_b64 s[22:23], vcc
    global_store_dwordx4 v6, v[32:35], s[16:17] sc0 sc1
    s_mov_b64 exec, s[22:23]
    s_lshl_b32 s21, s20, 6
    s_lshl_b32 s22, s18, 4
    s_add_u32 s21, s21, s22
    v_add_u32 v6, s21, v3
    v_lshlrev_b32 v6, 13, v6
    v_lshl_add_u32 v6, v2, 4, v6
    s_lshl_b32 s22, s19, 8
    v_add_u32 v6, s22, v6
    s_mov_b32 s24, s12
    s_mov_b32 s25, s13
    global_load_dwordx4 a[16:19], v6, s[24:25] nt
    s_add_u32 s24, s24, 32768
    s_addc_u32 s25, s25, 0
    global_load_dwordx4 a[20:23], v6, s[24:25] nt
    s_add_u32 s24, s24, 32768
    s_addc_u32 s25, s25, 0
    global_load_dwordx4 a[24:27], v6, s[24:25] nt
    s_add_u32 s24, s24, 32768
    s_addc_u32 s25, s25, 0
    global_load_dwordx4 a[28:31], v6, s[24:25] nt
    s_lshl_b32 s21, s19, 7
    s_lshl_b32 s22, s20, 4
    s_add_u32 s21, s21, s22
    v_add_u32 v6, s21, v3
    v_lshlrev_b32 v6, 10, v6
    v_lshl_add_u32 v6, v2, 4, v6
    s_lshl_b32 s22, s18, 8
    v_add_u32 v6, s22, v6
    s_mov_b32 s24, s14
    s_mov_b32 s25, s15
    global_load_dwordx4 a[0:3], v6, s[24:25] nt
    s_add_u32 s24, s24, 4096
    s_addc_u32 s25, s25, 0
    global_load_dwordx4 a[4:7], v6, s[24:25] nt
    s_add_u32 s24, s24, 4096
    s_addc_u32 s25, s25, 0
    global_load_dwordx4 a[8:11], v6, s[24:25] nt
    s_add_u32 s24, s24, 4096
    s_addc_u32 s25, s25, 0
    global_load_dwordx4 a[12:15], v6, s[24:25] nt
    s_mul_i32 s21, s2, 7
    v_add_u32 v6, s21, v3
    v_add_u32 v7, 4, v6
    v_min_u32 v7, 1791, v7
    v_lshlrev_b32 v6, 10, v6
    v_lshlrev_b32 v7, 10, v7
    v_lshl_add_u32 v6, v2, 4, v6
    v_lshl_add_u32 v7, v2, 4, v7
    s_lshl_b32 s22, s18, 8
    v_add_u32 v6, s22, v6
    v_add_u32 v7, s22, v7
    global_load_dwordx4 a[32:35], v6, s[40:41] nt
    global_load_dwordx4 a[36:39], v7, s[40:41] nt
    s_lshl_b32 s21, s30, 5
    s_lshl_b32 s22, s28, 4
    s_add_u32 s21, s21, s22
    v_add_u32 v14, s21, v2
    v_lshlrev_b32 v14, 11, v14
    v_lshl_add_u32 v14, v3, 5, v14
    s_lshl_b32 s22, s18, 9
    v_add_u32 v14, s22, v14
    v_add_u32 v14, 0x100000, v14
    global_load_dwordx4 v[128:131], v14, s[16:17] offset:0 sc0 sc1
    global_load_dwordx4 v[132:135], v14, s[16:17] offset:16 sc0 sc1
    global_load_dwordx4 v[136:139], v14, s[16:17] offset:128 sc0 sc1
    global_load_dwordx4 v[140:143], v14, s[16:17] offset:144 sc0 sc1
    global_load_dwordx4 v[144:147], v14, s[16:17] offset:256 sc0 sc1
    global_load_dwordx4 v[148:151], v14, s[16:17] offset:272 sc0 sc1
    global_load_dwordx4 v[152:155], v14, s[16:17] offset:384 sc0 sc1
    global_load_dwordx4 v[156:159], v14, s[16:17] offset:400 sc0 sc1
    v_mov_b32 v36, 0
    v_mov_b32 v37, 0
    v_mov_b32 v38, 0
    v_mov_b32 v39, 0
    s_waitcnt vmcnt(18)
    v_perm_b32 v24, v42, v42, v16
    v_perm_b32 v25, v42, v42, v18
    v_perm_b32 v26, v42, v42, v20
    v_perm_b32 v27, v42, v42, v22
    s_nop 1
    v_mfma_f32_16x16x32_bf16 v[36:39], v[64:67], v[24:27], v[36:39]
    v_perm_b32 v28, v42, v42, v17
    v_perm_b32 v29, v42, v42, v19
    v_perm_b32 v30, v42, v42, v21
    v_perm_b32 v31, v42, v42, v23
    s_nop 1
    v_mfma_f32_16x16x32_bf16 v[36:39], v[68:71], v[28:31], v[36:39]
    v_perm_b32 v24, v43, v43, v16
    v_perm_b32 v25, v43, v43, v18
    v_perm_b32 v26, v43, v43, v20
    v_perm_b32 v27, v43, v43, v22
    s_nop 1
    v_mfma_f32_16x16x32_bf16 v[36:39], v[72:75], v[24:27], v[36:39]
    v_perm_b32 v28, v43, v43, v17
    v_perm_b32 v29, v43, v43, v19
    v_perm_b32 v30, v43, v43, v21
    v_perm_b32 v31, v43, v43, v23
    s_nop 1
    v_mfma_f32_16x16x32_bf16 v[36:39], v[76:79], v[28:31], v[36:39]
    s_nop 7
    v_lshlrev_b32 v6, 4, v1
    s_lshl_b32 s21, s18, 10
    s_add_u32 s21, s21, 135168
    v_add_u32 v6, s21, v6
    ds_write_b128 v6, v[36:39]
    v_mov_b32 v45, 0
    v_lshlrev_b32 v4, 16, v100
    v_lshlrev_b32 v5, 16, v108
    v_fmac_f32 v45, v4, v5
    v_and_b32 v4, 0xffff0000, v100
    v_and_b32 v5, 0xffff0000, v108
    v_fmac_f32 v45, v4, v5

    v_lshlrev_b32 v4, 16, v101
    v_lshlrev_b32 v5, 16, v109
    v_fmac_f32 v45, v4, v5
    v_and_b32 v4, 0xffff0000, v101
    v_and_b32 v5, 0xffff0000, v109
    v_fmac_f32 v45, v4, v5

    v_lshlrev_b32 v4, 16, v102
    v_lshlrev_b32 v5, 16, v110
    v_fmac_f32 v45, v4, v5
    v_and_b32 v4, 0xffff0000, v102
    v_and_b32 v5, 0xffff0000, v110
    v_fmac_f32 v45, v4, v5

    v_lshlrev_b32 v4, 16, v103
    v_lshlrev_b32 v5, 16, v111
    v_fmac_f32 v45, v4, v5
    v_and_b32 v4, 0xffff0000, v103
    v_and_b32 v5, 0xffff0000, v111
    v_fmac_f32 v45, v4, v5

    v_mov_b32 v46, 0
    v_lshlrev_b32 v4, 16, v104
    v_lshlrev_b32 v5, 16, v108
    v_fmac_f32 v46, v4, v5
    v_and_b32 v4, 0xffff0000, v104
    v_and_b32 v5, 0xffff0000, v108
    v_fmac_f32 v46, v4, v5

    v_lshlrev_b32 v4, 16, v105
    v_lshlrev_b32 v5, 16, v109
    v_fmac_f32 v46, v4, v5
    v_and_b32 v4, 0xffff0000, v105
    v_and_b32 v5, 0xffff0000, v109
    v_fmac_f32 v46, v4, v5

    v_lshlrev_b32 v4, 16, v106
    v_lshlrev_b32 v5, 16, v110
    v_fmac_f32 v46, v4, v5
    v_and_b32 v4, 0xffff0000, v106
    v_and_b32 v5, 0xffff0000, v110
    v_fmac_f32 v46, v4, v5

    v_lshlrev_b32 v4, 16, v107
    v_lshlrev_b32 v5, 16, v111
    v_fmac_f32 v46, v4, v5
    v_and_b32 v4, 0xffff0000, v107
    v_and_b32 v5, 0xffff0000, v111
    v_fmac_f32 v46, v4, v5

    v_xor_b32 v6, 1, v1
    v_lshlrev_b32 v6, 2, v6
    ds_bpermute_b32 v4, v6, v45
    ds_bpermute_b32 v5, v6, v46
    s_waitcnt lgkmcnt(0)
    v_add_f32 v45, v45, v4
    v_add_f32 v46, v46, v5

    v_xor_b32 v6, 2, v1
    v_lshlrev_b32 v6, 2, v6
    ds_bpermute_b32 v4, v6, v45
    ds_bpermute_b32 v5, v6, v46
    s_waitcnt lgkmcnt(0)
    v_add_f32 v45, v45, v4
    v_add_f32 v46, v46, v5

    v_xor_b32 v6, 4, v1
    v_lshlrev_b32 v6, 2, v6
    ds_bpermute_b32 v4, v6, v45
    ds_bpermute_b32 v5, v6, v46
    s_waitcnt lgkmcnt(0)
    v_add_f32 v45, v45, v4
    v_add_f32 v46, v46, v5

    v_xor_b32 v6, 8, v1
    v_lshlrev_b32 v6, 2, v6
    ds_bpermute_b32 v4, v6, v45
    ds_bpermute_b32 v5, v6, v46
    s_waitcnt lgkmcnt(0)
    v_add_f32 v45, v45, v4
    v_add_f32 v46, v46, v5

    v_xor_b32 v6, 16, v1
    v_lshlrev_b32 v6, 2, v6
    ds_bpermute_b32 v4, v6, v45
    ds_bpermute_b32 v5, v6, v46
    s_waitcnt lgkmcnt(0)
    v_add_f32 v45, v45, v4
    v_add_f32 v46, v46, v5

    v_xor_b32 v6, 32, v1
    v_lshlrev_b32 v6, 2, v6
    ds_bpermute_b32 v4, v6, v45
    ds_bpermute_b32 v5, v6, v46
    s_waitcnt lgkmcnt(0)
    v_add_f32 v45, v45, v4
    v_add_f32 v46, v46, v5

    v_mul_f32 v45, 0xbfb8aa3b, v45
    v_mul_f32 v46, 0xbfb8aa3b, v46
    v_exp_f32 v45, v45
    v_exp_f32 v46, v46
    s_nop 0
    v_add_f32 v45, 1.0, v45
    v_add_f32 v46, 1.0, v46
    v_rcp_f32 v45, v45
    v_rcp_f32 v46, v46
    s_nop 0
    v_sub_f32 v4, 1.0, v45
    v_sub_f32 v5, 1.0, v46
    v_readfirstlane_b32 s50, v45
    v_readfirstlane_b32 s51, v46
    v_readfirstlane_b32 s52, v4
    v_readfirstlane_b32 s53, v5
    s_barrier
    v_lshlrev_b32 v6, 2, v0
    v_add_u32 v6, 135168, v6
    ds_read2st64_b32 v[52:53], v6 offset0:0 offset1:4
    ds_read2st64_b32 v[54:55], v6 offset0:8 offset1:12
    s_waitcnt lgkmcnt(0)
    v_add_f32 v52, v52, v53
    v_add_f32 v54, v54, v55
    v_add_f32 v52, v52, v54
    v_mov_b32 v53, s34
    v_lshrrev_b32 v12, 3, v8
    v_and_b32 v13, 7, v8
    v_lshl_add_u32 v13, v13, 3, v11
    s_lshl_b32 s21, s26, 6
    v_add_u32 v13, s21, v13
    s_lshl_b32 s21, s27, 1
    v_add_u32 v12, s21, v12
    v_lshl_add_u32 v12, v12, 1, v10
    s_movk_i32 s22, 1792
    v_mul_lo_u32 v12, v12, s22
    v_add_u32 v12, v12, v13
    v_lshlrev_b32 v12, 3, v12
    v_add_u32 v12, 0x80000, v12
    s_cmp_lt_u32 s2, 224
    s_cbranch_scc0 L_NOFFPUB
    global_store_dwordx2 v12, v[52:53], s[16:17] sc0 sc1
L_NOFFPUB:
    s_waitcnt vmcnt(0)
L_E2_CHK:
    v_xor_b32 v4, s34, v129
    v_xor_b32 v5, s34, v131
    v_or_b32 v4, v4, v5
    v_xor_b32 v5, s34, v133
    v_or_b32 v4, v4, v5
    v_xor_b32 v5, s34, v135
    v_or_b32 v4, v4, v5
    v_xor_b32 v5, s34, v137
    v_or_b32 v4, v4, v5
    v_xor_b32 v5, s34, v139
    v_or_b32 v4, v4, v5
    v_xor_b32 v5, s34, v141
    v_or_b32 v4, v4, v5
    v_xor_b32 v5, s34, v143
    v_or_b32 v4, v4, v5
    v_xor_b32 v5, s34, v145
    v_or_b32 v4, v4, v5
    v_xor_b32 v5, s34, v147
    v_or_b32 v4, v4, v5
    v_xor_b32 v5, s34, v149
    v_or_b32 v4, v4, v5
    v_xor_b32 v5, s34, v151
    v_or_b32 v4, v4, v5
    v_xor_b32 v5, s34, v153
    v_or_b32 v4, v4, v5
    v_xor_b32 v5, s34, v155
    v_or_b32 v4, v4, v5
    v_xor_b32 v5, s34, v157
    v_or_b32 v4, v4, v5
    v_xor_b32 v5, s34, v159
    v_or_b32 v4, v4, v5
    v_cmp_ne_u32 vcc, 0, v4
    s_cbranch_vccz L_E2_OK
    s_sub_u32 s35, s35, 1
    s_cbranch_scc1 L_EXIT
    s_sleep 1

    global_load_dwordx4 v[128:131], v14, s[16:17] offset:0 sc0 sc1
    global_load_dwordx4 v[132:135], v14, s[16:17] offset:16 sc0 sc1
    global_load_dwordx4 v[136:139], v14, s[16:17] offset:128 sc0 sc1
    global_load_dwordx4 v[140:143], v14, s[16:17] offset:144 sc0 sc1
    global_load_dwordx4 v[144:147], v14, s[16:17] offset:256 sc0 sc1
    global_load_dwordx4 v[148:151], v14, s[16:17] offset:272 sc0 sc1
    global_load_dwordx4 v[152:155], v14, s[16:17] offset:384 sc0 sc1
    global_load_dwordx4 v[156:159], v14, s[16:17] offset:400 sc0 sc1
    s_waitcnt vmcnt(0)
    s_branch L_E2_CHK
L_E2_OK:
    v_mov_b32 v96, v128
    v_mov_b32 v97, v130
    v_mov_b32 v98, v132
    v_mov_b32 v99, v134
    v_mov_b32 v100, v136
    v_mov_b32 v101, v138
    v_mov_b32 v102, v140
    v_mov_b32 v103, v142
    v_mov_b32 v104, v144
    v_mov_b32 v105, v146
    v_mov_b32 v106, v148
    v_mov_b32 v107, v150
    v_mov_b32 v108, v152
    v_mov_b32 v109, v154
    v_mov_b32 v110, v156
    v_mov_b32 v111, v158
    v_and_b32 v6, 7, v2
    v_lshlrev_b32 v6, 1, v6
    v_lshl_add_u32 v7, v2, 8, s33
    v_add_u32 v5, 0, v3
    v_xor_b32 v5, v5, v6
    v_lshl_add_u32 v8, v5, 4, v7
    v_add_u32 v5, 4, v3
    v_xor_b32 v5, v5, v6
    v_lshl_add_u32 v9, v5, 4, v7
    v_add_u32 v5, 8, v3
    v_xor_b32 v5, v5, v6
    v_lshl_add_u32 v10, v5, 4, v7
    v_add_u32 v5, 12, v3
    v_xor_b32 v5, v5, v6
    v_lshl_add_u32 v11, v5, 4, v7
    ds_read_b128 v[128:131], v8 offset:0
    ds_read_b128 v[132:135], v9 offset:0
    ds_read_b128 v[136:139], v10 offset:0
    ds_read_b128 v[140:143], v11 offset:0
    ds_read_b128 v[144:147], v8 offset:4096
    ds_read_b128 v[148:151], v9 offset:4096
    ds_read_b128 v[152:155], v10 offset:4096
    ds_read_b128 v[156:159], v11 offset:4096
    ds_read_b128 v[160:163], v8 offset:8192
    ds_read_b128 v[164:167], v9 offset:8192
    ds_read_b128 v[168:171], v10 offset:8192
    ds_read_b128 v[172:175], v11 offset:8192
    ds_read_b128 v[176:179], v8 offset:12288
    ds_read_b128 v[180:183], v9 offset:12288
    ds_read_b128 v[184:187], v10 offset:12288
    ds_read_b128 v[188:191], v11 offset:12288
    s_waitcnt lgkmcnt(12)
    v_mfma_f32_16x16x32_bf16 v[48:51], v[128:131], v[96:99], 0
    v_mfma_f32_16x16x32_bf16 v[48:51], v[132:135], v[100:103], v[48:51]
    v_mfma_f32_16x16x32_bf16 v[48:51], v[136:139], v[104:107], v[48:51]
    v_mfma_f32_16x16x32_bf16 v[48:51], v[140:143], v[108:111], v[48:51]
    ds_read_b128 v[192:195], v8 offset:16384
    ds_read_b128 v[196:199], v9 offset:16384
    ds_read_b128 v[200:203], v10 offset:16384
    ds_read_b128 v[204:207], v11 offset:16384
    s_waitcnt lgkmcnt(12)
    v_mfma_f32_16x16x32_bf16 v[52:55], v[144:147], v[96:99], 0
    v_mfma_f32_16x16x32_bf16 v[52:55], v[148:151], v[100:103], v[52:55]
    v_mfma_f32_16x16x32_bf16 v[52:55], v[152:155], v[104:107], v[52:55]
    v_mfma_f32_16x16x32_bf16 v[52:55], v[156:159], v[108:111], v[52:55]
    ds_read_b128 v[208:211], v8 offset:20480
    ds_read_b128 v[212:215], v9 offset:20480
    ds_read_b128 v[216:219], v10 offset:20480
    ds_read_b128 v[220:223], v11 offset:20480
    s_waitcnt lgkmcnt(12)
    v_mfma_f32_16x16x32_bf16 v[56:59], v[160:163], v[96:99], 0
    v_mfma_f32_16x16x32_bf16 v[56:59], v[164:167], v[100:103], v[56:59]
    v_mfma_f32_16x16x32_bf16 v[56:59], v[168:171], v[104:107], v[56:59]
    v_mfma_f32_16x16x32_bf16 v[56:59], v[172:175], v[108:111], v[56:59]
    ds_read_b128 v[224:227], v8 offset:24576
    ds_read_b128 v[228:231], v9 offset:24576
    ds_read_b128 v[232:235], v10 offset:24576
    ds_read_b128 v[236:239], v11 offset:24576
    s_waitcnt lgkmcnt(12)
    v_mfma_f32_16x16x32_bf16 v[60:63], v[176:179], v[96:99], 0
    v_mfma_f32_16x16x32_bf16 v[60:63], v[180:183], v[100:103], v[60:63]
    v_mfma_f32_16x16x32_bf16 v[60:63], v[184:187], v[104:107], v[60:63]
    v_mfma_f32_16x16x32_bf16 v[60:63], v[188:191], v[108:111], v[60:63]
    ds_read_b128 v[240:243], v8 offset:28672
    ds_read_b128 v[244:247], v9 offset:28672
    ds_read_b128 v[248:251], v10 offset:28672
    ds_read_b128 v[252:255], v11 offset:28672
    s_waitcnt lgkmcnt(12)
    v_mfma_f32_16x16x32_bf16 v[64:67], v[192:195], v[96:99], 0
    v_mfma_f32_16x16x32_bf16 v[64:67], v[196:199], v[100:103], v[64:67]
    v_mfma_f32_16x16x32_bf16 v[64:67], v[200:203], v[104:107], v[64:67]
    v_mfma_f32_16x16x32_bf16 v[64:67], v[204:207], v[108:111], v[64:67]
    s_waitcnt lgkmcnt(8)
    v_mfma_f32_16x16x32_bf16 v[68:71], v[208:211], v[96:99], 0
    v_mfma_f32_16x16x32_bf16 v[68:71], v[212:215], v[100:103], v[68:71]
    v_mfma_f32_16x16x32_bf16 v[68:71], v[216:219], v[104:107], v[68:71]
    v_mfma_f32_16x16x32_bf16 v[68:71], v[220:223], v[108:111], v[68:71]
    s_waitcnt lgkmcnt(4)
    v_mfma_f32_16x16x32_bf16 v[72:75], v[224:227], v[96:99], 0
    v_mfma_f32_16x16x32_bf16 v[72:75], v[228:231], v[100:103], v[72:75]
    v_mfma_f32_16x16x32_bf16 v[72:75], v[232:235], v[104:107], v[72:75]
    v_mfma_f32_16x16x32_bf16 v[72:75], v[236:239], v[108:111], v[72:75]
    s_waitcnt lgkmcnt(0)
    v_mfma_f32_16x16x32_bf16 v[76:79], v[240:243], v[96:99], 0
    v_mfma_f32_16x16x32_bf16 v[76:79], v[244:247], v[100:103], v[76:79]
    v_mfma_f32_16x16x32_bf16 v[76:79], v[248:251], v[104:107], v[76:79]
    v_mfma_f32_16x16x32_bf16 v[76:79], v[252:255], v[108:111], v[76:79]
    s_nop 7
    v_lshlrev_b32 v9, 4, v1
    v_add_u32 v9, 131072, v9
    s_lshl_b32 s24, s18, 13
    v_add_u32 v10, s24, v9
    s_barrier
    ds_write_b128 v10, v[48:51] offset:0
    ds_write_b128 v10, v[52:55] offset:1024
    ds_write_b128 v10, v[56:59] offset:2048
    ds_write_b128 v10, v[60:63] offset:3072
    ds_write_b128 v10, v[64:67] offset:4096
    ds_write_b128 v10, v[68:71] offset:5120
    ds_write_b128 v10, v[72:75] offset:6144
    ds_write_b128 v10, v[76:79] offset:7168
    s_waitcnt lgkmcnt(0)
    s_barrier
    s_add_u32 s24, s18, 1
    s_and_b32 s24, s24, 3
    s_lshl_b32 s24, s24, 13
    v_add_u32 v10, s24, v9

    ds_read_b128 v[128:131], v10 offset:0
    ds_read_b128 v[132:135], v10 offset:1024
    ds_read_b128 v[136:139], v10 offset:2048
    ds_read_b128 v[140:143], v10 offset:3072
    ds_read_b128 v[144:147], v10 offset:4096
    ds_read_b128 v[148:151], v10 offset:5120
    ds_read_b128 v[152:155], v10 offset:6144
    ds_read_b128 v[156:159], v10 offset:7168
    s_add_u32 s24, s18, 2
    s_and_b32 s24, s24, 3
    s_lshl_b32 s24, s24, 13
    v_add_u32 v10, s24, v9

    ds_read_b128 v[160:163], v10 offset:0
    ds_read_b128 v[164:167], v10 offset:1024
    ds_read_b128 v[168:171], v10 offset:2048
    ds_read_b128 v[172:175], v10 offset:3072
    ds_read_b128 v[176:179], v10 offset:4096
    ds_read_b128 v[180:183], v10 offset:5120
    ds_read_b128 v[184:187], v10 offset:6144
    ds_read_b128 v[188:191], v10 offset:7168
    s_add_u32 s24, s18, 3
    s_and_b32 s24, s24, 3
    s_lshl_b32 s24, s24, 13
    v_add_u32 v10, s24, v9

    ds_read_b128 v[192:195], v10 offset:0
    ds_read_b128 v[196:199], v10 offset:1024
    ds_read_b128 v[200:203], v10 offset:2048
    ds_read_b128 v[204:207], v10 offset:3072
    ds_read_b128 v[208:211], v10 offset:4096
    ds_read_b128 v[212:215], v10 offset:5120
    ds_read_b128 v[216:219], v10 offset:6144
    ds_read_b128 v[220:223], v10 offset:7168
    s_waitcnt lgkmcnt(15)
    v_add_f32 v48, v48, v128
    v_add_f32 v49, v49, v129
    v_add_f32 v50, v50, v130
    v_add_f32 v51, v51, v131
    v_add_f32 v52, v52, v132
    v_add_f32 v53, v53, v133
    v_add_f32 v54, v54, v134
    v_add_f32 v55, v55, v135
    v_add_f32 v56, v56, v136
    v_add_f32 v57, v57, v137
    v_add_f32 v58, v58, v138
    v_add_f32 v59, v59, v139
    v_add_f32 v60, v60, v140
    v_add_f32 v61, v61, v141
    v_add_f32 v62, v62, v142
    v_add_f32 v63, v63, v143
    v_add_f32 v64, v64, v144
    v_add_f32 v65, v65, v145
    v_add_f32 v66, v66, v146
    v_add_f32 v67, v67, v147
    v_add_f32 v68, v68, v148
    v_add_f32 v69, v69, v149
    v_add_f32 v70, v70, v150
    v_add_f32 v71, v71, v151
    v_add_f32 v72, v72, v152
    v_add_f32 v73, v73, v153
    v_add_f32 v74, v74, v154
    v_add_f32 v75, v75, v155
    v_add_f32 v76, v76, v156
    v_add_f32 v77, v77, v157
    v_add_f32 v78, v78, v158
    v_add_f32 v79, v79, v159
    s_waitcnt lgkmcnt(8)
    v_add_f32 v48, v48, v160
    v_add_f32 v49, v49, v161
    v_add_f32 v50, v50, v162
    v_add_f32 v51, v51, v163
    v_add_f32 v52, v52, v164
    v_add_f32 v53, v53, v165
    v_add_f32 v54, v54, v166
    v_add_f32 v55, v55, v167
    v_add_f32 v56, v56, v168
    v_add_f32 v57, v57, v169
    v_add_f32 v58, v58, v170
    v_add_f32 v59, v59, v171
    v_add_f32 v60, v60, v172
    v_add_f32 v61, v61, v173
    v_add_f32 v62, v62, v174
    v_add_f32 v63, v63, v175
    v_add_f32 v64, v64, v176
    v_add_f32 v65, v65, v177
    v_add_f32 v66, v66, v178
    v_add_f32 v67, v67, v179
    v_add_f32 v68, v68, v180
    v_add_f32 v69, v69, v181
    v_add_f32 v70, v70, v182
    v_add_f32 v71, v71, v183
    v_add_f32 v72, v72, v184
    v_add_f32 v73, v73, v185
    v_add_f32 v74, v74, v186
    v_add_f32 v75, v75, v187
    v_add_f32 v76, v76, v188
    v_add_f32 v77, v77, v189
    v_add_f32 v78, v78, v190
    v_add_f32 v79, v79, v191
    s_waitcnt lgkmcnt(0)
    v_add_f32 v48, v48, v192
    v_add_f32 v49, v49, v193
    v_add_f32 v50, v50, v194
    v_add_f32 v51, v51, v195
    v_add_f32 v52, v52, v196
    v_add_f32 v53, v53, v197
    v_add_f32 v54, v54, v198
    v_add_f32 v55, v55, v199
    v_add_f32 v56, v56, v200
    v_add_f32 v57, v57, v201
    v_add_f32 v58, v58, v202
    v_add_f32 v59, v59, v203
    v_add_f32 v60, v60, v204
    v_add_f32 v61, v61, v205
    v_add_f32 v62, v62, v206
    v_add_f32 v63, v63, v207
    v_add_f32 v64, v64, v208
    v_add_f32 v65, v65, v209
    v_add_f32 v66, v66, v210
    v_add_f32 v67, v67, v211
    v_add_f32 v68, v68, v212
    v_add_f32 v69, v69, v213
    v_add_f32 v70, v70, v214
    v_add_f32 v71, v71, v215
    v_add_f32 v72, v72, v216
    v_add_f32 v73, v73, v217
    v_add_f32 v74, v74, v218
    v_add_f32 v75, v75, v219
    v_add_f32 v76, v76, v220
    v_add_f32 v77, v77, v221
    v_add_f32 v78, v78, v222
    v_add_f32 v79, v79, v223
    v_max_f32 v11, v48, v49
    v_max3_f32 v11, v11, v50, v51
    v_max3_f32 v11, v11, v52, v53
    v_max3_f32 v11, v11, v54, v55
    v_max3_f32 v11, v11, v56, v57
    v_max3_f32 v11, v11, v58, v59
    v_max3_f32 v11, v11, v60, v61
    v_max3_f32 v11, v11, v62, v63
    v_max3_f32 v11, v11, v64, v65
    v_max3_f32 v11, v11, v66, v67
    v_max3_f32 v11, v11, v68, v69
    v_max3_f32 v11, v11, v70, v71
    v_max3_f32 v11, v11, v72, v73
    v_max3_f32 v11, v11, v74, v75
    v_max3_f32 v11, v11, v76, v77
    v_max3_f32 v11, v11, v78, v79
    v_xor_b32 v12, 16, v1
    v_lshlrev_b32 v12, 2, v12
    v_xor_b32 v13, 32, v1
    v_lshlrev_b32 v13, 2, v13
    ds_bpermute_b32 v14, v12, v11
    s_waitcnt lgkmcnt(0)
    v_max_f32 v11, v11, v14
    ds_bpermute_b32 v14, v13, v11
    s_waitcnt lgkmcnt(0)
    v_max_f32 v11, v11, v14
    v_sub_f32 v48, v48, v11
    v_sub_f32 v49, v49, v11
    v_sub_f32 v50, v50, v11
    v_sub_f32 v51, v51, v11
    v_sub_f32 v52, v52, v11
    v_sub_f32 v53, v53, v11
    v_sub_f32 v54, v54, v11
    v_sub_f32 v55, v55, v11
    v_sub_f32 v56, v56, v11
    v_sub_f32 v57, v57, v11
    v_sub_f32 v58, v58, v11
    v_sub_f32 v59, v59, v11
    v_sub_f32 v60, v60, v11
    v_sub_f32 v61, v61, v11
    v_sub_f32 v62, v62, v11
    v_sub_f32 v63, v63, v11
    v_sub_f32 v64, v64, v11
    v_sub_f32 v65, v65, v11
    v_sub_f32 v66, v66, v11
    v_sub_f32 v67, v67, v11
    v_sub_f32 v68, v68, v11
    v_sub_f32 v69, v69, v11
    v_sub_f32 v70, v70, v11
    v_sub_f32 v71, v71, v11
    v_sub_f32 v72, v72, v11
    v_sub_f32 v73, v73, v11
    v_sub_f32 v74, v74, v11
    v_sub_f32 v75, v75, v11
    v_sub_f32 v76, v76, v11
    v_sub_f32 v77, v77, v11
    v_sub_f32 v78, v78, v11
    v_sub_f32 v79, v79, v11
    v_exp_f32 v48, v48
    v_exp_f32 v49, v49
    v_exp_f32 v50, v50
    v_exp_f32 v51, v51
    v_exp_f32 v52, v52
    v_exp_f32 v53, v53
    v_exp_f32 v54, v54
    v_exp_f32 v55, v55
    v_exp_f32 v56, v56
    v_exp_f32 v57, v57
    v_exp_f32 v58, v58
    v_exp_f32 v59, v59
    v_exp_f32 v60, v60
    v_exp_f32 v61, v61
    v_exp_f32 v62, v62
    v_exp_f32 v63, v63
    v_exp_f32 v64, v64
    v_exp_f32 v65, v65
    v_exp_f32 v66, v66
    v_exp_f32 v67, v67
    v_exp_f32 v68, v68
    v_exp_f32 v69, v69
    v_exp_f32 v70, v70
    v_exp_f32 v71, v71
    v_exp_f32 v72, v72
    v_exp_f32 v73, v73
    v_exp_f32 v74, v74
    v_exp_f32 v75, v75
    v_exp_f32 v76, v76
    v_exp_f32 v77, v77
    v_exp_f32 v78, v78
    v_exp_f32 v79, v79
    s_nop 0
    v_add_f32 v15, v48, v49
    v_add_f32 v15, v15, v50
    v_add_f32 v15, v15, v51
    v_add_f32 v15, v15, v52
    v_add_f32 v15, v15, v53
    v_add_f32 v15, v15, v54
    v_add_f32 v15, v15, v55
    v_add_f32 v15, v15, v56
    v_add_f32 v15, v15, v57
    v_add_f32 v15, v15, v58
    v_add_f32 v15, v15, v59
    v_add_f32 v15, v15, v60
    v_add_f32 v15, v15, v61
    v_add_f32 v15, v15, v62
    v_add_f32 v15, v15, v63
    v_add_f32 v15, v15, v64
    v_add_f32 v15, v15, v65
    v_add_f32 v15, v15, v66
    v_add_f32 v15, v15, v67
    v_add_f32 v15, v15, v68
    v_add_f32 v15, v15, v69
    v_add_f32 v15, v15, v70
    v_add_f32 v15, v15, v71
    v_add_f32 v15, v15, v72
    v_add_f32 v15, v15, v73
    v_add_f32 v15, v15, v74
    v_add_f32 v15, v15, v75
    v_add_f32 v15, v15, v76
    v_add_f32 v15, v15, v77
    v_add_f32 v15, v15, v78
    v_add_f32 v15, v15, v79
    ds_bpermute_b32 v14, v12, v15
    s_waitcnt lgkmcnt(0)
    v_add_f32 v15, v15, v14
    ds_bpermute_b32 v14, v13, v15
    s_waitcnt lgkmcnt(0)
    v_add_f32 v15, v15, v14
    v_cvt_pk_bf16_f32 v112, v48, v49
    v_cvt_pk_bf16_f32 v113, v50, v51
    v_cvt_pk_bf16_f32 v114, v52, v53
    v_cvt_pk_bf16_f32 v115, v54, v55
    v_cvt_pk_bf16_f32 v116, v56, v57
    v_cvt_pk_bf16_f32 v117, v58, v59
    v_cvt_pk_bf16_f32 v118, v60, v61
    v_cvt_pk_bf16_f32 v119, v62, v63
    v_cvt_pk_bf16_f32 v120, v64, v65
    v_cvt_pk_bf16_f32 v121, v66, v67
    v_cvt_pk_bf16_f32 v122, v68, v69
    v_cvt_pk_bf16_f32 v123, v70, v71
    v_cvt_pk_bf16_f32 v124, v72, v73
    v_cvt_pk_bf16_f32 v125, v74, v75
    v_cvt_pk_bf16_f32 v126, v76, v77
    v_cvt_pk_bf16_f32 v127, v78, v79
    v_mov_b32 v24, v11
    v_mov_b32 v25, s34
    v_mov_b32 v26, v15
    v_mov_b32 v27, s34
    s_lshl_b32 s24, s30, 5
    s_lshl_b32 s25, s28, 4
    s_add_u32 s24, s24, s25
    v_add_u32 v6, s24, v2
    v_lshlrev_b32 v6, 6, v6
    v_add_u32 v6, s31, v6
    v_lshlrev_b32 v7, 4, v6
    v_add_u32 v7, 0x140000, v7
    s_cmp_eq_u32 s18, 0
    s_cbranch_scc0 L_NOML
    v_cmp_gt_u32 vcc, 16, v1
    s_and_saveexec_b64 s[22:23], vcc
    global_store_dwordx4 v7, v[24:27], s[16:17] sc0 sc1
    s_mov_b64 exec, s[22:23]
L_NOML:
    v_lshrrev_b32 v12, 2, v2
    v_lshl_add_u32 v13, v3, 2, v12
    v_lshlrev_b32 v14, 8, v13
    v_and_b32 v13, 7, v13
    v_lshl_add_u32 v14, v13, 5, v14
    v_and_b32 v13, 3, v2
    v_lshl_add_u32 v14, v13, 3, v14
    v_add_u32 v14, s33, v14
    v_xor_b32 v128, 0, v14
    v_xor_b32 v129, 32, v14
    v_xor_b32 v130, 64, v14
    v_xor_b32 v131, 96, v14
    v_xor_b32 v132, 128, v14
    v_xor_b32 v133, 160, v14
    v_xor_b32 v134, 192, v14
    v_xor_b32 v135, 224, v14
    ds_read_b64_tr_b16 v[80:81], v128 offset:0
    ds_read_b64_tr_b16 v[82:83], v128 offset:4096
    ds_read_b64_tr_b16 v[84:85], v128 offset:8192
    ds_read_b64_tr_b16 v[86:87], v128 offset:12288
    ds_read_b64_tr_b16 v[88:89], v128 offset:16384
    ds_read_b64_tr_b16 v[90:91], v128 offset:20480
    ds_read_b64_tr_b16 v[92:93], v128 offset:24576
    ds_read_b64_tr_b16 v[94:95], v128 offset:28672
    ds_read_b64_tr_b16 v[96:97], v129 offset:0
    ds_read_b64_tr_b16 v[98:99], v129 offset:4096
    s_waitcnt lgkmcnt(8)
    v_mfma_f32_16x16x32_bf16 v[48:51], v[80:83], v[112:115], 0
    ds_read_b64_tr_b16 v[100:101], v129 offset:8192
    ds_read_b64_tr_b16 v[102:103], v129 offset:12288
    s_waitcnt lgkmcnt(8)
    v_mfma_f32_16x16x32_bf16 v[48:51], v[84:87], v[116:119], v[48:51]
    ds_read_b64_tr_b16 v[104:105], v129 offset:16384
    ds_read_b64_tr_b16 v[106:107], v129 offset:20480
    s_waitcnt lgkmcnt(8)
    v_mfma_f32_16x16x32_bf16 v[48:51], v[88:91], v[120:123], v[48:51]
    ds_read_b64_tr_b16 v[108:109], v129 offset:24576
    ds_read_b64_tr_b16 v[110:111], v129 offset:28672
    s_waitcnt lgkmcnt(8)
    v_mfma_f32_16x16x32_bf16 v[48:51], v[92:95], v[124:127], v[48:51]
    ds_read_b64_tr_b16 v[80:81], v130 offset:0
    ds_read_b64_tr_b16 v[82:83], v130 offset:4096
    s_waitcnt lgkmcnt(8)
    v_mfma_f32_16x16x32_bf16 v[52:55], v[96:99], v[112:115], 0
    ds_read_b64_tr_b16 v[84:85], v130 offset:8192
    ds_read_b64_tr_b16 v[86:87], v130 offset:12288
    s_waitcnt lgkmcnt(8)
    v_mfma_f32_16x16x32_bf16 v[52:55], v[100:103], v[116:119], v[52:55]
    ds_read_b64_tr_b16 v[88:89], v130 offset:16384
    ds_read_b64_tr_b16 v[90:91], v130 offset:20480
    s_waitcnt lgkmcnt(8)
    v_mfma_f32_16x16x32_bf16 v[52:55], v[104:107], v[120:123], v[52:55]
    ds_read_b64_tr_b16 v[92:93], v130 offset:24576
    ds_read_b64_tr_b16 v[94:95], v130 offset:28672
    s_waitcnt lgkmcnt(8)
    v_mfma_f32_16x16x32_bf16 v[52:55], v[108:111], v[124:127], v[52:55]
    ds_read_b64_tr_b16 v[96:97], v131 offset:0
    ds_read_b64_tr_b16 v[98:99], v131 offset:4096
    s_waitcnt lgkmcnt(8)
    v_mfma_f32_16x16x32_bf16 v[56:59], v[80:83], v[112:115], 0
    ds_read_b64_tr_b16 v[100:101], v131 offset:8192
    ds_read_b64_tr_b16 v[102:103], v131 offset:12288
    s_waitcnt lgkmcnt(8)
    v_mfma_f32_16x16x32_bf16 v[56:59], v[84:87], v[116:119], v[56:59]
    ds_read_b64_tr_b16 v[104:105], v131 offset:16384
    ds_read_b64_tr_b16 v[106:107], v131 offset:20480
    s_waitcnt lgkmcnt(8)
    v_mfma_f32_16x16x32_bf16 v[56:59], v[88:91], v[120:123], v[56:59]
    ds_read_b64_tr_b16 v[108:109], v131 offset:24576
    ds_read_b64_tr_b16 v[110:111], v131 offset:28672
    s_waitcnt lgkmcnt(8)
    v_mfma_f32_16x16x32_bf16 v[56:59], v[92:95], v[124:127], v[56:59]
    ds_read_b64_tr_b16 v[80:81], v132 offset:0
    ds_read_b64_tr_b16 v[82:83], v132 offset:4096
    s_waitcnt lgkmcnt(8)
    v_mfma_f32_16x16x32_bf16 v[60:63], v[96:99], v[112:115], 0
    ds_read_b64_tr_b16 v[84:85], v132 offset:8192
    ds_read_b64_tr_b16 v[86:87], v132 offset:12288
    s_waitcnt lgkmcnt(8)
    v_mfma_f32_16x16x32_bf16 v[60:63], v[100:103], v[116:119], v[60:63]
    ds_read_b64_tr_b16 v[88:89], v132 offset:16384
    ds_read_b64_tr_b16 v[90:91], v132 offset:20480
    s_waitcnt lgkmcnt(8)
    v_mfma_f32_16x16x32_bf16 v[60:63], v[104:107], v[120:123], v[60:63]
    ds_read_b64_tr_b16 v[92:93], v132 offset:24576
    ds_read_b64_tr_b16 v[94:95], v132 offset:28672
    s_waitcnt lgkmcnt(8)
    v_mfma_f32_16x16x32_bf16 v[60:63], v[108:111], v[124:127], v[60:63]
    ds_read_b64_tr_b16 v[96:97], v133 offset:0
    ds_read_b64_tr_b16 v[98:99], v133 offset:4096
    s_waitcnt lgkmcnt(8)
    v_mfma_f32_16x16x32_bf16 v[64:67], v[80:83], v[112:115], 0
    ds_read_b64_tr_b16 v[100:101], v133 offset:8192
    ds_read_b64_tr_b16 v[102:103], v133 offset:12288
    s_waitcnt lgkmcnt(8)
    v_mfma_f32_16x16x32_bf16 v[64:67], v[84:87], v[116:119], v[64:67]
    ds_read_b64_tr_b16 v[104:105], v133 offset:16384
    ds_read_b64_tr_b16 v[106:107], v133 offset:20480
    s_waitcnt lgkmcnt(8)
    v_mfma_f32_16x16x32_bf16 v[64:67], v[88:91], v[120:123], v[64:67]
    ds_read_b64_tr_b16 v[108:109], v133 offset:24576
    ds_read_b64_tr_b16 v[110:111], v133 offset:28672
    s_waitcnt lgkmcnt(8)
    v_mfma_f32_16x16x32_bf16 v[64:67], v[92:95], v[124:127], v[64:67]
    ds_read_b64_tr_b16 v[80:81], v134 offset:0
    ds_read_b64_tr_b16 v[82:83], v134 offset:4096
    s_waitcnt lgkmcnt(8)
    v_mfma_f32_16x16x32_bf16 v[68:71], v[96:99], v[112:115], 0
    ds_read_b64_tr_b16 v[84:85], v134 offset:8192
    ds_read_b64_tr_b16 v[86:87], v134 offset:12288
    s_waitcnt lgkmcnt(8)
    v_mfma_f32_16x16x32_bf16 v[68:71], v[100:103], v[116:119], v[68:71]
    ds_read_b64_tr_b16 v[88:89], v134 offset:16384
    ds_read_b64_tr_b16 v[90:91], v134 offset:20480
    s_waitcnt lgkmcnt(8)
    v_mfma_f32_16x16x32_bf16 v[68:71], v[104:107], v[120:123], v[68:71]
    ds_read_b64_tr_b16 v[92:93], v134 offset:24576
    ds_read_b64_tr_b16 v[94:95], v134 offset:28672
    s_waitcnt lgkmcnt(8)
    v_mfma_f32_16x16x32_bf16 v[68:71], v[108:111], v[124:127], v[68:71]
    ds_read_b64_tr_b16 v[96:97], v135 offset:0
    ds_read_b64_tr_b16 v[98:99], v135 offset:4096
    s_waitcnt lgkmcnt(8)
    v_mfma_f32_16x16x32_bf16 v[72:75], v[80:83], v[112:115], 0
    ds_read_b64_tr_b16 v[100:101], v135 offset:8192
    ds_read_b64_tr_b16 v[102:103], v135 offset:12288
    s_waitcnt lgkmcnt(8)
    v_mfma_f32_16x16x32_bf16 v[72:75], v[84:87], v[116:119], v[72:75]
    ds_read_b64_tr_b16 v[104:105], v135 offset:16384
    ds_read_b64_tr_b16 v[106:107], v135 offset:20480
    s_waitcnt lgkmcnt(8)
    v_mfma_f32_16x16x32_bf16 v[72:75], v[88:91], v[120:123], v[72:75]
    ds_read_b64_tr_b16 v[108:109], v135 offset:24576
    ds_read_b64_tr_b16 v[110:111], v135 offset:28672
    s_waitcnt lgkmcnt(8)
    v_mfma_f32_16x16x32_bf16 v[72:75], v[92:95], v[124:127], v[72:75]
    s_waitcnt lgkmcnt(6)
    v_mfma_f32_16x16x32_bf16 v[76:79], v[96:99], v[112:115], 0
    s_waitcnt lgkmcnt(4)
    v_mfma_f32_16x16x32_bf16 v[76:79], v[100:103], v[116:119], v[76:79]
    s_waitcnt lgkmcnt(2)
    v_mfma_f32_16x16x32_bf16 v[76:79], v[104:107], v[120:123], v[76:79]
    s_waitcnt lgkmcnt(0)
    v_mfma_f32_16x16x32_bf16 v[76:79], v[108:111], v[124:127], v[76:79]
    s_nop 7
    v_lshlrev_b32 v6, 11, v6
    v_lshl_add_u32 v6, v3, 4, v6
    s_lshl_b32 s25, s18, 9
    v_add_u32 v6, s25, v6
    v_add_u32 v6, 0x400000, v6
    v_cvt_pk_bf16_f32 v80, v48, v49
    v_mov_b32 v81, s34
    v_cvt_pk_bf16_f32 v82, v50, v51
    v_mov_b32 v83, s34
    global_store_dwordx4 v6, v[80:83], s[16:17] offset:0 sc0 sc1
    v_cvt_pk_bf16_f32 v84, v52, v53
    v_mov_b32 v85, s34
    v_cvt_pk_bf16_f32 v86, v54, v55
    v_mov_b32 v87, s34
    global_store_dwordx4 v6, v[84:87], s[16:17] offset:64 sc0 sc1
    v_cvt_pk_bf16_f32 v88, v56, v57
    v_mov_b32 v89, s34
    v_cvt_pk_bf16_f32 v90, v58, v59
    v_mov_b32 v91, s34
    global_store_dwordx4 v6, v[88:91], s[16:17] offset:128 sc0 sc1
    v_cvt_pk_bf16_f32 v92, v60, v61
    v_mov_b32 v93, s34
    v_cvt_pk_bf16_f32 v94, v62, v63
    v_mov_b32 v95, s34
    global_store_dwordx4 v6, v[92:95], s[16:17] offset:192 sc0 sc1
    v_cvt_pk_bf16_f32 v96, v64, v65
    v_mov_b32 v97, s34
    v_cvt_pk_bf16_f32 v98, v66, v67
    v_mov_b32 v99, s34
    global_store_dwordx4 v6, v[96:99], s[16:17] offset:256 sc0 sc1
    v_cvt_pk_bf16_f32 v100, v68, v69
    v_mov_b32 v101, s34
    v_cvt_pk_bf16_f32 v102, v70, v71
    v_mov_b32 v103, s34
    global_store_dwordx4 v6, v[100:103], s[16:17] offset:320 sc0 sc1
    v_cvt_pk_bf16_f32 v104, v72, v73
    v_mov_b32 v105, s34
    v_cvt_pk_bf16_f32 v106, v74, v75
    v_mov_b32 v107, s34
    global_store_dwordx4 v6, v[104:107], s[16:17] offset:384 sc0 sc1
    v_cvt_pk_bf16_f32 v108, v76, v77
    v_mov_b32 v109, s34
    v_cvt_pk_bf16_f32 v110, v78, v79
    v_mov_b32 v111, s34
    global_store_dwordx4 v6, v[108:111], s[16:17] offset:448 sc0 sc1
    v_and_b32 v6, 7, v1
    s_mul_i32 s21, s2, 7
    v_add_u32 v6, s21, v6
    v_min_u32 v6, 1791, v6
    v_bfe_u32 v7, v1, 3, 1
    s_movk_i32 s22, 1792
    v_mul_lo_u32 v7, v7, s22
    v_add_u32 v6, v6, v7
    v_lshlrev_b32 v6, 3, v6
    v_add_u32 v13, 0x80000, v6
    s_mov_b32 s24, s16
    s_mov_b32 s25, s17
    global_load_dwordx2 v[128:129], v13, s[24:25] sc0 sc1
    s_add_u32 s24, s24, 28672
    s_addc_u32 s25, s25, 0
    global_load_dwordx2 v[130:131], v13, s[24:25] sc0 sc1
    s_add_u32 s24, s24, 28672
    s_addc_u32 s25, s25, 0
    global_load_dwordx2 v[132:133], v13, s[24:25] sc0 sc1
    s_add_u32 s24, s24, 28672
    s_addc_u32 s25, s25, 0
    global_load_dwordx2 v[134:135], v13, s[24:25] sc0 sc1
    s_add_u32 s24, s24, 28672
    s_addc_u32 s25, s25, 0
    global_load_dwordx2 v[136:137], v13, s[24:25] sc0 sc1
    s_add_u32 s24, s24, 28672
    s_addc_u32 s25, s25, 0
    global_load_dwordx2 v[138:139], v13, s[24:25] sc0 sc1
    s_add_u32 s24, s24, 28672
    s_addc_u32 s25, s25, 0
    global_load_dwordx2 v[140:141], v13, s[24:25] sc0 sc1
    s_add_u32 s24, s24, 28672
    s_addc_u32 s25, s25, 0
    global_load_dwordx2 v[142:143], v13, s[24:25] sc0 sc1
    s_add_u32 s24, s24, 28672
    s_addc_u32 s25, s25, 0
    global_load_dwordx2 v[144:145], v13, s[24:25] sc0 sc1
    s_add_u32 s24, s24, 28672
    s_addc_u32 s25, s25, 0
    global_load_dwordx2 v[146:147], v13, s[24:25] sc0 sc1
    s_add_u32 s24, s24, 28672
    s_addc_u32 s25, s25, 0
    global_load_dwordx2 v[148:149], v13, s[24:25] sc0 sc1
    s_add_u32 s24, s24, 28672
    s_addc_u32 s25, s25, 0
    global_load_dwordx2 v[150:151], v13, s[24:25] sc0 sc1
    s_add_u32 s24, s24, 28672
    s_addc_u32 s25, s25, 0
    global_load_dwordx2 v[152:153], v13, s[24:25] sc0 sc1
    s_add_u32 s24, s24, 28672
    s_addc_u32 s25, s25, 0
    global_load_dwordx2 v[154:155], v13, s[24:25] sc0 sc1
    s_add_u32 s24, s24, 28672
    s_addc_u32 s25, s25, 0
    global_load_dwordx2 v[156:157], v13, s[24:25] sc0 sc1
    s_add_u32 s24, s24, 28672
    s_addc_u32 s25, s25, 0
    global_load_dwordx2 v[158:159], v13, s[24:25] sc0 sc1
    v_lshrrev_b32 v6, 4, v0
    v_and_b32 v7, 15, v0
    v_lshlrev_b32 v8, 11, v6
    v_lshl_add_u32 v8, v7, 4, v8
    s_lshl_b32 s21, s19, 17
    s_lshl_b32 s22, s20, 8
    s_add_u32 s21, s21, s22
    s_add_u32 s21, s21, 0x400000
    v_add_u32 v8, s21, v8
    v_lshlrev_b32 v9, 4, v6
    s_lshl_b32 s21, s19, 10
    s_add_u32 s21, s21, 0x140000
    v_add_u32 v9, s21, v9
    v_add_u32 v10, 32768, v9
    s_mov_b32 s24, s16
    s_mov_b32 s25, s17
    global_load_dwordx4 v[48:51], v8, s[24:25] sc0 sc1
    s_add_u32 s24, s24, 32768
    s_addc_u32 s25, s25, 0
    global_load_dwordx4 v[52:55], v8, s[24:25] sc0 sc1
    s_add_u32 s24, s24, 32768
    s_addc_u32 s25, s25, 0
    global_load_dwordx4 v[56:59], v8, s[24:25] sc0 sc1
    s_add_u32 s24, s24, 32768
    s_addc_u32 s25, s25, 0
    global_load_dwordx4 v[60:63], v8, s[24:25] sc0 sc1
    s_add_u32 s24, s24, 4096000
    s_addc_u32 s25, s25, 0
    global_load_dwordx4 v[64:67], v8, s[24:25] sc0 sc1
    s_add_u32 s24, s24, 32768
    s_addc_u32 s25, s25, 0
    global_load_dwordx4 v[68:71], v8, s[24:25] sc0 sc1
    s_add_u32 s24, s24, 32768
    s_addc_u32 s25, s25, 0
    global_load_dwordx4 v[72:75], v8, s[24:25] sc0 sc1
    s_add_u32 s24, s24, 32768
    s_addc_u32 s25, s25, 0
    global_load_dwordx4 v[76:79], v8, s[24:25] sc0 sc1
    global_load_dwordx4 v[80:83], v9, s[16:17] offset:0 sc0 sc1
    global_load_dwordx4 v[84:87], v9, s[16:17] offset:256 sc0 sc1
    global_load_dwordx4 v[88:91], v9, s[16:17] offset:512 sc0 sc1
    global_load_dwordx4 v[92:95], v9, s[16:17] offset:768 sc0 sc1
    global_load_dwordx4 v[96:99], v10, s[16:17] offset:0 sc0 sc1
    global_load_dwordx4 v[100:103], v10, s[16:17] offset:256 sc0 sc1
    global_load_dwordx4 v[104:107], v10, s[16:17] offset:512 sc0 sc1
    global_load_dwordx4 v[108:111], v10, s[16:17] offset:768 sc0 sc1
    s_waitcnt vmcnt(16)
L_FF_CHK:
    v_xor_b32 v4, s34, v129
    v_xor_b32 v5, s34, v131
    v_or_b32 v4, v4, v5
    v_xor_b32 v5, s34, v133
    v_or_b32 v4, v4, v5
    v_xor_b32 v5, s34, v135
    v_or_b32 v4, v4, v5
    v_xor_b32 v5, s34, v137
    v_or_b32 v4, v4, v5
    v_xor_b32 v5, s34, v139
    v_or_b32 v4, v4, v5
    v_xor_b32 v5, s34, v141
    v_or_b32 v4, v4, v5
    v_xor_b32 v5, s34, v143
    v_or_b32 v4, v4, v5
    v_xor_b32 v5, s34, v145
    v_or_b32 v4, v4, v5
    v_xor_b32 v5, s34, v147
    v_or_b32 v4, v4, v5
    v_xor_b32 v5, s34, v149
    v_or_b32 v4, v4, v5
    v_xor_b32 v5, s34, v151
    v_or_b32 v4, v4, v5
    v_xor_b32 v5, s34, v153
    v_or_b32 v4, v4, v5
    v_xor_b32 v5, s34, v155
    v_or_b32 v4, v4, v5
    v_xor_b32 v5, s34, v157
    v_or_b32 v4, v4, v5
    v_xor_b32 v5, s34, v159
    v_or_b32 v4, v4, v5
    v_cmp_ne_u32 vcc, 0, v4
    s_cbranch_vccz L_FF_OK
    s_sub_u32 s35, s35, 1
    s_cbranch_scc1 L_EXIT
    s_sleep 1

    s_mov_b32 s24, s16
    s_mov_b32 s25, s17
    global_load_dwordx2 v[128:129], v13, s[24:25] sc0 sc1
    s_add_u32 s24, s24, 28672
    s_addc_u32 s25, s25, 0
    global_load_dwordx2 v[130:131], v13, s[24:25] sc0 sc1
    s_add_u32 s24, s24, 28672
    s_addc_u32 s25, s25, 0
    global_load_dwordx2 v[132:133], v13, s[24:25] sc0 sc1
    s_add_u32 s24, s24, 28672
    s_addc_u32 s25, s25, 0
    global_load_dwordx2 v[134:135], v13, s[24:25] sc0 sc1
    s_add_u32 s24, s24, 28672
    s_addc_u32 s25, s25, 0
    global_load_dwordx2 v[136:137], v13, s[24:25] sc0 sc1
    s_add_u32 s24, s24, 28672
    s_addc_u32 s25, s25, 0
    global_load_dwordx2 v[138:139], v13, s[24:25] sc0 sc1
    s_add_u32 s24, s24, 28672
    s_addc_u32 s25, s25, 0
    global_load_dwordx2 v[140:141], v13, s[24:25] sc0 sc1
    s_add_u32 s24, s24, 28672
    s_addc_u32 s25, s25, 0
    global_load_dwordx2 v[142:143], v13, s[24:25] sc0 sc1
    s_add_u32 s24, s24, 28672
    s_addc_u32 s25, s25, 0
    global_load_dwordx2 v[144:145], v13, s[24:25] sc0 sc1
    s_add_u32 s24, s24, 28672
    s_addc_u32 s25, s25, 0
    global_load_dwordx2 v[146:147], v13, s[24:25] sc0 sc1
    s_add_u32 s24, s24, 28672
    s_addc_u32 s25, s25, 0
    global_load_dwordx2 v[148:149], v13, s[24:25] sc0 sc1
    s_add_u32 s24, s24, 28672
    s_addc_u32 s25, s25, 0
    global_load_dwordx2 v[150:151], v13, s[24:25] sc0 sc1
    s_add_u32 s24, s24, 28672
    s_addc_u32 s25, s25, 0
    global_load_dwordx2 v[152:153], v13, s[24:25] sc0 sc1
    s_add_u32 s24, s24, 28672
    s_addc_u32 s25, s25, 0
    global_load_dwordx2 v[154:155], v13, s[24:25] sc0 sc1
    s_add_u32 s24, s24, 28672
    s_addc_u32 s25, s25, 0
    global_load_dwordx2 v[156:157], v13, s[24:25] sc0 sc1
    s_add_u32 s24, s24, 28672
    s_addc_u32 s25, s25, 0
    global_load_dwordx2 v[158:159], v13, s[24:25] sc0 sc1
    s_waitcnt vmcnt(0)
    s_branch L_FF_CHK
L_FF_OK:
    v_add_f32 v128, v128, v132
    v_add_f32 v130, v130, v134
    v_add_f32 v128, v128, v136
    v_add_f32 v130, v130, v138
    v_add_f32 v128, v128, v140
    v_add_f32 v130, v130, v142
    v_add_f32 v128, v128, v144
    v_add_f32 v130, v130, v146
    v_add_f32 v128, v128, v148
    v_add_f32 v130, v130, v150
    v_add_f32 v128, v128, v152
    v_add_f32 v130, v130, v154
    v_add_f32 v128, v128, v156
    v_add_f32 v130, v130, v158
    v_mul_f32 v132, v128, v128
    v_mul_f32 v132, v132, v128
    v_mov_b32 v133, 0x3d372713
    v_fma_f32 v132, v132, v133, v128
    v_mul_f32 v132, 0xc0135761, v132
    v_exp_f32 v132, v132
    s_nop 0
    v_add_f32 v132, 1.0, v132
    v_rcp_f32 v132, v132
    s_nop 0
    v_mul_f32 v132, v132, v128
    v_mul_f32 v132, v132, v130
    v_mov_b32 v133, s52
    v_mov_b32 v134, s53
    v_bfe_u32 v7, v1, 3, 1
    v_cmp_eq_u32 vcc, 1, v7
    s_nop 1
    v_cndmask_b32 v133, v133, v134, vcc
    v_mul_f32 v132, v132, v133
    v_and_b32 v7, 7, v1
    v_cmp_eq_u32 vcc, 7, v7
    s_nop 1
    v_cndmask_b32 v132, v132, 0, vcc
    v_cvt_pk_bf16_f32 v132, v132, v132
    v_lshrrev_b32 v7, 3, v2
    v_lshlrev_b32 v7, 3, v7
    v_add_u32 v7, v7, v3
    v_lshlrev_b32 v7, 2, v7
    ds_bpermute_b32 v124, v7, v132
    v_add_u32 v7, 16, v7
    ds_bpermute_b32 v125, v7, v132
    s_waitcnt vmcnt(0)
L_E3_CHK:
    v_xor_b32 v4, s34, v49
    v_xor_b32 v5, s34, v51
    v_or_b32 v4, v4, v5
    v_xor_b32 v5, s34, v53
    v_or_b32 v4, v4, v5
    v_xor_b32 v5, s34, v55
    v_or_b32 v4, v4, v5
    v_xor_b32 v5, s34, v57
    v_or_b32 v4, v4, v5
    v_xor_b32 v5, s34, v59
    v_or_b32 v4, v4, v5
    v_xor_b32 v5, s34, v61
    v_or_b32 v4, v4, v5
    v_xor_b32 v5, s34, v63
    v_or_b32 v4, v4, v5
    v_xor_b32 v5, s34, v65
    v_or_b32 v4, v4, v5
    v_xor_b32 v5, s34, v67
    v_or_b32 v4, v4, v5
    v_xor_b32 v5, s34, v69
    v_or_b32 v4, v4, v5
    v_xor_b32 v5, s34, v71
    v_or_b32 v4, v4, v5
    v_xor_b32 v5, s34, v73
    v_or_b32 v4, v4, v5
    v_xor_b32 v5, s34, v75
    v_or_b32 v4, v4, v5
    v_xor_b32 v5, s34, v77
    v_or_b32 v4, v4, v5
    v_xor_b32 v5, s34, v79
    v_or_b32 v4, v4, v5
    v_xor_b32 v5, s34, v81
    v_or_b32 v4, v4, v5
    v_xor_b32 v5, s34, v83
    v_or_b32 v4, v4, v5
    v_xor_b32 v5, s34, v85
    v_or_b32 v4, v4, v5
    v_xor_b32 v5, s34, v87
    v_or_b32 v4, v4, v5
    v_xor_b32 v5, s34, v89
    v_or_b32 v4, v4, v5
    v_xor_b32 v5, s34, v91
    v_or_b32 v4, v4, v5
    v_xor_b32 v5, s34, v93
    v_or_b32 v4, v4, v5
    v_xor_b32 v5, s34, v95
    v_or_b32 v4, v4, v5
    v_xor_b32 v5, s34, v97
    v_or_b32 v4, v4, v5
    v_xor_b32 v5, s34, v99
    v_or_b32 v4, v4, v5
    v_xor_b32 v5, s34, v101
    v_or_b32 v4, v4, v5
    v_xor_b32 v5, s34, v103
    v_or_b32 v4, v4, v5
    v_xor_b32 v5, s34, v105
    v_or_b32 v4, v4, v5
    v_xor_b32 v5, s34, v107
    v_or_b32 v4, v4, v5
    v_xor_b32 v5, s34, v109
    v_or_b32 v4, v4, v5
    v_xor_b32 v5, s34, v111
    v_or_b32 v4, v4, v5
    v_cmp_ne_u32 vcc, 0, v4
    s_cbranch_vccz L_E3_OK
    s_sub_u32 s35, s35, 1
    s_cbranch_scc1 L_EXIT
    s_sleep 1

    s_mov_b32 s24, s16
    s_mov_b32 s25, s17
    global_load_dwordx4 v[48:51], v8, s[24:25] sc0 sc1
    s_add_u32 s24, s24, 32768
    s_addc_u32 s25, s25, 0
    global_load_dwordx4 v[52:55], v8, s[24:25] sc0 sc1
    s_add_u32 s24, s24, 32768
    s_addc_u32 s25, s25, 0
    global_load_dwordx4 v[56:59], v8, s[24:25] sc0 sc1
    s_add_u32 s24, s24, 32768
    s_addc_u32 s25, s25, 0
    global_load_dwordx4 v[60:63], v8, s[24:25] sc0 sc1
    s_add_u32 s24, s24, 4096000
    s_addc_u32 s25, s25, 0
    global_load_dwordx4 v[64:67], v8, s[24:25] sc0 sc1
    s_add_u32 s24, s24, 32768
    s_addc_u32 s25, s25, 0
    global_load_dwordx4 v[68:71], v8, s[24:25] sc0 sc1
    s_add_u32 s24, s24, 32768
    s_addc_u32 s25, s25, 0
    global_load_dwordx4 v[72:75], v8, s[24:25] sc0 sc1
    s_add_u32 s24, s24, 32768
    s_addc_u32 s25, s25, 0
    global_load_dwordx4 v[76:79], v8, s[24:25] sc0 sc1
    global_load_dwordx4 v[80:83], v9, s[16:17] offset:0 sc0 sc1
    global_load_dwordx4 v[84:87], v9, s[16:17] offset:256 sc0 sc1
    global_load_dwordx4 v[88:91], v9, s[16:17] offset:512 sc0 sc1
    global_load_dwordx4 v[92:95], v9, s[16:17] offset:768 sc0 sc1
    global_load_dwordx4 v[96:99], v10, s[16:17] offset:0 sc0 sc1
    global_load_dwordx4 v[100:103], v10, s[16:17] offset:256 sc0 sc1
    global_load_dwordx4 v[104:107], v10, s[16:17] offset:512 sc0 sc1
    global_load_dwordx4 v[108:111], v10, s[16:17] offset:768 sc0 sc1
    s_waitcnt vmcnt(0)
    s_branch L_E3_CHK
L_E3_OK:
    v_max_f32 v112, v80, v84
    v_max3_f32 v112, v112, v88, v92
    v_sub_f32 v116, v80, v112
    v_sub_f32 v117, v84, v112
    v_sub_f32 v118, v88, v112
    v_sub_f32 v119, v92, v112
    v_exp_f32 v116, v116
    v_exp_f32 v117, v117
    v_exp_f32 v118, v118
    v_exp_f32 v119, v119
    s_nop 0
    v_mul_f32 v113, v116, v82
    v_fmac_f32 v113, v117, v86
    v_fmac_f32 v113, v118, v90
    v_fmac_f32 v113, v119, v94
    v_lshlrev_b32 v114, 16, v48
    v_and_b32 v115, 0xffff0000, v48
    v_mul_f32 v120, v114, v116
    v_mul_f32 v121, v115, v116
    v_lshlrev_b32 v114, 16, v50
    v_and_b32 v115, 0xffff0000, v50
    v_mul_f32 v122, v114, v116
    v_mul_f32 v123, v115, v116
    v_lshlrev_b32 v114, 16, v52
    v_and_b32 v115, 0xffff0000, v52
    v_fmac_f32 v120, v114, v117
    v_fmac_f32 v121, v115, v117
    v_lshlrev_b32 v114, 16, v54
    v_and_b32 v115, 0xffff0000, v54
    v_fmac_f32 v122, v114, v117
    v_fmac_f32 v123, v115, v117
    v_lshlrev_b32 v114, 16, v56
    v_and_b32 v115, 0xffff0000, v56
    v_fmac_f32 v120, v114, v118
    v_fmac_f32 v121, v115, v118
    v_lshlrev_b32 v114, 16, v58
    v_and_b32 v115, 0xffff0000, v58
    v_fmac_f32 v122, v114, v118
    v_fmac_f32 v123, v115, v118
    v_lshlrev_b32 v114, 16, v60
    v_and_b32 v115, 0xffff0000, v60
    v_fmac_f32 v120, v114, v119
    v_fmac_f32 v121, v115, v119
    v_lshlrev_b32 v114, 16, v62
    v_and_b32 v115, 0xffff0000, v62
    v_fmac_f32 v122, v114, v119
    v_fmac_f32 v123, v115, v119
    v_lshrrev_b32 v6, 4, v0
    v_and_b32 v7, 15, v0
    v_lshlrev_b32 v11, 9, v6
    v_lshl_add_u32 v11, v7, 4, v11
    v_add_u32 v11, 131072, v11
    v_lshlrev_b32 v12, 4, v6
    v_add_u32 v12, 139264, v12
    s_barrier

    ds_write_b128 v11, v[120:123] offset:0
    ds_write_b64 v12, v[112:113] offset:0
    v_max_f32 v112, v96, v100
    v_max3_f32 v112, v112, v104, v108
    v_sub_f32 v116, v96, v112
    v_sub_f32 v117, v100, v112
    v_sub_f32 v118, v104, v112
    v_sub_f32 v119, v108, v112
    v_exp_f32 v116, v116
    v_exp_f32 v117, v117
    v_exp_f32 v118, v118
    v_exp_f32 v119, v119
    s_nop 0
    v_mul_f32 v113, v116, v98
    v_fmac_f32 v113, v117, v102
    v_fmac_f32 v113, v118, v106
    v_fmac_f32 v113, v119, v110
    v_lshlrev_b32 v114, 16, v64
    v_and_b32 v115, 0xffff0000, v64
    v_mul_f32 v120, v114, v116
    v_mul_f32 v121, v115, v116
    v_lshlrev_b32 v114, 16, v66
    v_and_b32 v115, 0xffff0000, v66
    v_mul_f32 v122, v114, v116
    v_mul_f32 v123, v115, v116
    v_lshlrev_b32 v114, 16, v68
    v_and_b32 v115, 0xffff0000, v68
    v_fmac_f32 v120, v114, v117
    v_fmac_f32 v121, v115, v117
    v_lshlrev_b32 v114, 16, v70
    v_and_b32 v115, 0xffff0000, v70
    v_fmac_f32 v122, v114, v117
    v_fmac_f32 v123, v115, v117
    v_lshlrev_b32 v114, 16, v72
    v_and_b32 v115, 0xffff0000, v72
    v_fmac_f32 v120, v114, v118
    v_fmac_f32 v121, v115, v118
    v_lshlrev_b32 v114, 16, v74
    v_and_b32 v115, 0xffff0000, v74
    v_fmac_f32 v122, v114, v118
    v_fmac_f32 v123, v115, v118
    v_lshlrev_b32 v114, 16, v76
    v_and_b32 v115, 0xffff0000, v76
    v_fmac_f32 v120, v114, v119
    v_fmac_f32 v121, v115, v119
    v_lshlrev_b32 v114, 16, v78
    v_and_b32 v115, 0xffff0000, v78
    v_fmac_f32 v122, v114, v119
    v_fmac_f32 v123, v115, v119
    ds_write_b128 v11, v[120:123] offset:256
    ds_write_b64 v12, v[112:113] offset:8
    s_waitcnt lgkmcnt(0)
    s_barrier
    s_cmp_lt_u32 s18, 2
    s_cbranch_scc0 L_P4_NOSUM
    v_lshlrev_b32 v9, 2, v0
    v_add_u32 v9, 131072, v9
    s_lshl_b32 s21, s18, 3
    s_add_u32 s21, s21, 139264
    v_mov_b32 v10, s21
    ds_read2st64_b32 v[48:49], v9 offset0:0 offset1:2
    ds_read2st64_b32 v[50:51], v9 offset0:4 offset1:6
    ds_read2st64_b32 v[52:53], v9 offset0:8 offset1:10
    ds_read2st64_b32 v[54:55], v9 offset0:12 offset1:14
    ds_read2st64_b32 v[56:57], v9 offset0:16 offset1:18
    ds_read2st64_b32 v[58:59], v9 offset0:20 offset1:22
    ds_read2st64_b32 v[60:61], v9 offset0:24 offset1:26
    ds_read2st64_b32 v[62:63], v9 offset0:28 offset1:30
    ds_read_b64 v[64:65], v10 offset:0
    ds_read_b64 v[66:67], v10 offset:16
    ds_read_b64 v[68:69], v10 offset:32
    ds_read_b64 v[70:71], v10 offset:48
    ds_read_b64 v[72:73], v10 offset:64
    ds_read_b64 v[74:75], v10 offset:80
    ds_read_b64 v[76:77], v10 offset:96
    ds_read_b64 v[78:79], v10 offset:112
    ds_read_b64 v[80:81], v10 offset:128
    ds_read_b64 v[82:83], v10 offset:144
    ds_read_b64 v[84:85], v10 offset:160
    ds_read_b64 v[86:87], v10 offset:176
    ds_read_b64 v[88:89], v10 offset:192
    ds_read_b64 v[90:91], v10 offset:208
    ds_read_b64 v[92:93], v10 offset:224
    ds_read_b64 v[94:95], v10 offset:240
    s_waitcnt lgkmcnt(0)
    v_max_f32 v112, v64, v66
    v_max3_f32 v112, v112, v68, v70
    v_max3_f32 v112, v112, v72, v74
    v_max3_f32 v112, v112, v76, v78
    v_max3_f32 v112, v112, v80, v82
    v_max3_f32 v112, v112, v84, v86
    v_max3_f32 v112, v112, v88, v90
    v_max3_f32 v112, v112, v92, v94
    v_sub_f32 v64, v64, v112
    v_sub_f32 v66, v66, v112
    v_sub_f32 v68, v68, v112
    v_sub_f32 v70, v70, v112
    v_sub_f32 v72, v72, v112
    v_sub_f32 v74, v74, v112
    v_sub_f32 v76, v76, v112
    v_sub_f32 v78, v78, v112
    v_sub_f32 v80, v80, v112
    v_sub_f32 v82, v82, v112
    v_sub_f32 v84, v84, v112
    v_sub_f32 v86, v86, v112
    v_sub_f32 v88, v88, v112
    v_sub_f32 v90, v90, v112
    v_sub_f32 v92, v92, v112
    v_sub_f32 v94, v94, v112
    v_exp_f32 v64, v64
    v_exp_f32 v66, v66
    v_exp_f32 v68, v68
    v_exp_f32 v70, v70
    v_exp_f32 v72, v72
    v_exp_f32 v74, v74
    v_exp_f32 v76, v76
    v_exp_f32 v78, v78
    v_exp_f32 v80, v80
    v_exp_f32 v82, v82
    v_exp_f32 v84, v84
    v_exp_f32 v86, v86
    v_exp_f32 v88, v88
    v_exp_f32 v90, v90
    v_exp_f32 v92, v92
    v_exp_f32 v94, v94
    s_nop 0
    v_mul_f32 v113, v64, v65
    v_mul_f32 v114, v64, v48
    v_fmac_f32 v113, v66, v67
    v_fmac_f32 v114, v66, v49
    v_fmac_f32 v113, v68, v69
    v_fmac_f32 v114, v68, v50
    v_fmac_f32 v113, v70, v71
    v_fmac_f32 v114, v70, v51
    v_fmac_f32 v113, v72, v73
    v_fmac_f32 v114, v72, v52
    v_fmac_f32 v113, v74, v75
    v_fmac_f32 v114, v74, v53
    v_fmac_f32 v113, v76, v77
    v_fmac_f32 v114, v76, v54
    v_fmac_f32 v113, v78, v79
    v_fmac_f32 v114, v78, v55
    v_fmac_f32 v113, v80, v81
    v_fmac_f32 v114, v80, v56
    v_fmac_f32 v113, v82, v83
    v_fmac_f32 v114, v82, v57
    v_fmac_f32 v113, v84, v85
    v_fmac_f32 v114, v84, v58
    v_fmac_f32 v113, v86, v87
    v_fmac_f32 v114, v86, v59
    v_fmac_f32 v113, v88, v89
    v_fmac_f32 v114, v88, v60
    v_fmac_f32 v113, v90, v91
    v_fmac_f32 v114, v90, v61
    v_fmac_f32 v113, v92, v93
    v_fmac_f32 v114, v92, v62
    v_fmac_f32 v113, v94, v95
    v_fmac_f32 v114, v94, v63
    v_rcp_f32 v113, v113
    s_nop 0
    v_mul_f32 v114, v114, v113
    v_cvt_pk_bf16_f32 v114, v114, v114
    v_lshlrev_b32 v9, 1, v0
    v_add_u32 v9, 139776, v9
    ds_write_b16 v9, v114
L_P4_NOSUM:
    s_waitcnt lgkmcnt(0)
    s_barrier
    v_lshrrev_b32 v9, 3, v2
    v_lshlrev_b32 v9, 7, v9
    v_lshl_add_u32 v9, v3, 1, v9
    s_lshl_b32 s21, s18, 5
    s_add_u32 s21, s21, 139776
    v_add_u32 v9, s21, v9
    ds_read_u16 v48, v9
    ds_read_u16 v49, v9 offset:8
    ds_read_u16 v50, v9 offset:16
    ds_read_u16 v51, v9 offset:24
    v_mov_b32 v32, 0
    v_mov_b32 v33, 0
    v_mov_b32 v34, 0
    v_mov_b32 v35, 0
    s_waitcnt lgkmcnt(0)
    v_perm_b32 v24, v48, v48, v16
    v_perm_b32 v25, v48, v48, v18
    v_perm_b32 v26, v48, v48, v20
    v_perm_b32 v27, v48, v48, v22
    s_nop 1
    v_mfma_f32_16x16x32_bf16 v[32:35], a[16:19], v[24:27], v[32:35]
    v_perm_b32 v28, v49, v49, v16
    v_perm_b32 v29, v49, v49, v18
    v_perm_b32 v30, v49, v49, v20
    v_perm_b32 v31, v49, v49, v22
    s_nop 1
    v_mfma_f32_16x16x32_bf16 v[32:35], a[20:23], v[28:31], v[32:35]
    v_perm_b32 v24, v50, v50, v16
    v_perm_b32 v25, v50, v50, v18
    v_perm_b32 v26, v50, v50, v20
    v_perm_b32 v27, v50, v50, v22
    s_nop 1
    v_mfma_f32_16x16x32_bf16 v[32:35], a[24:27], v[24:27], v[32:35]
    v_perm_b32 v28, v51, v51, v16
    v_perm_b32 v29, v51, v51, v18
    v_perm_b32 v30, v51, v51, v20
    v_perm_b32 v31, v51, v51, v22
    s_nop 1
    v_mfma_f32_16x16x32_bf16 v[32:35], a[28:31], v[28:31], v[32:35]
    s_nop 7
    v_lshlrev_b32 v9, 4, v1
    s_lshl_b32 s21, s18, 10
    s_add_u32 s21, s21, 143360
    v_add_u32 v9, s21, v9
    ds_write_b128 v9, v[32:35]
    s_waitcnt lgkmcnt(0)
    s_barrier
    v_lshlrev_b32 v9, 2, v0
    v_add_u32 v9, 143360, v9
    ds_read2st64_b32 v[48:49], v9 offset0:0 offset1:4
    ds_read2st64_b32 v[50:51], v9 offset0:8 offset1:12
    v_lshrrev_b32 v7, 2, v0
    v_and_b32 v52, 3, v0
    v_lshrrev_b32 v53, 4, v7
    v_lshl_add_u32 v52, v53, 2, v52
    v_and_b32 v53, 15, v7
    v_lshrrev_b32 v54, 3, v53
    v_and_b32 v55, 7, v53
    v_lshl_add_u32 v56, v52, 3, v55
    v_lshl_add_u32 v56, v54, 7, v56
    s_lshl_b32 s21, s19, 3
    s_add_u32 s21, s21, s20
    s_lshl_b32 s21, s21, 8
    v_add_u32 v56, s21, v56
    v_lshlrev_b32 v56, 3, v56
    v_add_u32 v56, 0x180000, v56
    s_waitcnt lgkmcnt(0)
    v_add_f32 v48, v48, v49
    v_add_f32 v50, v50, v51
    v_add_f32 v48, v48, v50
    v_mov_b32 v49, s34
    global_store_dwordx2 v56, v[48:49], s[16:17] sc0 sc1
    v_bfe_u32 v6, v1, 4, 1
    v_lshlrev_b32 v6, 7, v6
    v_add_u32 v6, v6, v2
    s_lshl_b32 s21, s19, 11
    s_lshl_b32 s22, s20, 4
    s_add_u32 s21, s21, s22
    v_add_u32 v6, s21, v6
    v_lshlrev_b32 v6, 3, v6
    v_add_u32 v10, 0x180000, v6
    v_add_u32 v11, 4096, v10
    v_add_u32 v14, 8192, v10
    v_add_u32 v9, 12288, v10
L_CX_POLL:
    global_load_dwordx2 v[48:49], v10, s[16:17] offset:0 sc0 sc1
    global_load_dwordx2 v[50:51], v10, s[16:17] offset:2048 sc0 sc1
    global_load_dwordx2 v[52:53], v11, s[16:17] offset:0 sc0 sc1
    global_load_dwordx2 v[54:55], v11, s[16:17] offset:2048 sc0 sc1
    global_load_dwordx2 v[56:57], v14, s[16:17] offset:0 sc0 sc1
    global_load_dwordx2 v[58:59], v14, s[16:17] offset:2048 sc0 sc1
    global_load_dwordx2 v[60:61], v9, s[16:17] offset:0 sc0 sc1
    global_load_dwordx2 v[62:63], v9, s[16:17] offset:2048 sc0 sc1
    s_waitcnt vmcnt(0)
    v_xor_b32 v4, s34, v49
    v_xor_b32 v5, s34, v51
    v_or_b32 v4, v4, v5
    v_xor_b32 v5, s34, v53
    v_or_b32 v4, v4, v5
    v_xor_b32 v5, s34, v55
    v_or_b32 v4, v4, v5
    v_xor_b32 v5, s34, v57
    v_or_b32 v4, v4, v5
    v_xor_b32 v5, s34, v59
    v_or_b32 v4, v4, v5
    v_xor_b32 v5, s34, v61
    v_or_b32 v4, v4, v5
    v_xor_b32 v5, s34, v63
    v_or_b32 v4, v4, v5
    v_cmp_ne_u32 vcc, 0, v4
    s_cbranch_vccz L_CX_OK
    s_sub_u32 s35, s35, 1
    s_cbranch_scc1 L_EXIT
    s_sleep 1

    s_branch L_CX_POLL
L_CX_OK:
    v_add_f32 v48, v48, v50
    v_add_f32 v52, v52, v54
    v_add_f32 v56, v56, v58
    v_add_f32 v60, v60, v62
    v_add_f32 v48, v48, v52
    v_add_f32 v56, v56, v60
    v_add_f32 v48, v48, v56
    v_mov_b32 v49, s50
    v_mov_b32 v50, s51
    v_bfe_u32 v7, v1, 4, 1
    v_cmp_eq_u32 vcc, 1, v7
    s_nop 1
    v_cndmask_b32 v49, v49, v50, vcc
    v_mul_f32 v48, v48, v49
    v_cvt_pk_bf16_f32 v48, v48, v48
    v_lshrrev_b32 v7, 3, v2
    v_lshlrev_b32 v7, 4, v7
    v_add_u32 v7, v7, v3
    v_lshlrev_b32 v7, 2, v7
    ds_bpermute_b32 v120, v7, v48
    v_add_u32 v7, 16, v7
    ds_bpermute_b32 v121, v7, v48
    v_add_u32 v7, 16, v7
    ds_bpermute_b32 v122, v7, v48
    v_add_u32 v7, 16, v7
    ds_bpermute_b32 v123, v7, v48
    v_mov_b32 v32, 0
    v_mov_b32 v33, 0
    v_mov_b32 v34, 0
    v_mov_b32 v35, 0
    s_waitcnt lgkmcnt(0)
    v_perm_b32 v24, v120, v120, v16
    v_perm_b32 v25, v120, v120, v18
    v_perm_b32 v26, v120, v120, v20
    v_perm_b32 v27, v120, v120, v22
    s_nop 1
    v_mfma_f32_16x16x32_bf16 v[32:35], a[0:3], v[24:27], v[32:35]
    v_perm_b32 v28, v121, v121, v16
    v_perm_b32 v29, v121, v121, v18
    v_perm_b32 v30, v121, v121, v20
    v_perm_b32 v31, v121, v121, v22
    s_nop 1
    v_mfma_f32_16x16x32_bf16 v[32:35], a[4:7], v[28:31], v[32:35]
    v_perm_b32 v24, v122, v122, v16
    v_perm_b32 v25, v122, v122, v18
    v_perm_b32 v26, v122, v122, v20
    v_perm_b32 v27, v122, v122, v22
    s_nop 1
    v_mfma_f32_16x16x32_bf16 v[32:35], a[8:11], v[24:27], v[32:35]
    v_perm_b32 v28, v123, v123, v16
    v_perm_b32 v29, v123, v123, v18
    v_perm_b32 v30, v123, v123, v20
    v_perm_b32 v31, v123, v123, v22
    s_nop 1
    v_mfma_f32_16x16x32_bf16 v[32:35], a[12:15], v[28:31], v[32:35]
    v_perm_b32 v24, v124, v124, v16
    v_perm_b32 v25, v124, v124, v18
    v_perm_b32 v26, v124, v124, v20
    v_perm_b32 v27, v124, v124, v22
    s_nop 1
    v_mfma_f32_16x16x32_bf16 v[32:35], a[32:35], v[24:27], v[32:35]
    v_perm_b32 v28, v125, v125, v16
    v_perm_b32 v29, v125, v125, v18
    v_perm_b32 v30, v125, v125, v20
    v_perm_b32 v31, v125, v125, v22
    s_nop 1
    v_mfma_f32_16x16x32_bf16 v[32:35], a[36:39], v[28:31], v[32:35]
    s_nop 7
    v_lshrrev_b32 v6, 3, v2
    v_lshlrev_b32 v6, 9, v6
    v_lshl_add_u32 v6, v3, 5, v6
    v_and_b32 v7, 7, v2
    v_add_u32 v6, v6, v7
    s_lshl_b32 s21, s18, 7
    v_add_u32 v6, s21, v6
    s_lshl_b32 s21, s2, 10
    v_add_u32 v6, s21, v6
    v_lshlrev_b32 v6, 3, v6
    v_add_u32 v6, 0x200000, v6
    v_mov_b32 v48, v32
    v_mov_b32 v49, s34
    global_store_dwordx2 v6, v[48:49], s[16:17] offset:0 sc0 sc1
    v_mov_b32 v50, v33
    v_mov_b32 v51, s34
    global_store_dwordx2 v6, v[50:51], s[16:17] offset:64 sc0 sc1
    v_mov_b32 v52, v34
    v_mov_b32 v53, s34
    global_store_dwordx2 v6, v[52:53], s[16:17] offset:128 sc0 sc1
    v_mov_b32 v54, v35
    v_mov_b32 v55, s34
    global_store_dwordx2 v6, v[54:55], s[16:17] offset:192 sc0 sc1
    s_cmp_lt_u32 s2, 64
    s_cbranch_scc0 L_END
    v_lshrrev_b32 v6, 3, v0
    v_and_b32 v7, 7, v0
    v_lshlrev_b32 v8, 13, v6
    v_lshl_add_u32 v8, v7, 4, v8
    s_lshl_b32 s21, s2, 7
    s_add_u32 s21, s21, 0x200000
    v_add_u32 v8, s21, v8
L_E4_POLL:
    s_mov_b32 s24, s16
    s_mov_b32 s25, s17
    global_load_dwordx4 v[48:51], v8, s[24:25] sc0 sc1
    s_add_u32 s24, s24, 262144
    s_addc_u32 s25, s25, 0
    global_load_dwordx4 v[52:55], v8, s[24:25] sc0 sc1
    s_add_u32 s24, s24, 262144
    s_addc_u32 s25, s25, 0
    global_load_dwordx4 v[56:59], v8, s[24:25] sc0 sc1
    s_add_u32 s24, s24, 262144
    s_addc_u32 s25, s25, 0
    global_load_dwordx4 v[60:63], v8, s[24:25] sc0 sc1
    s_add_u32 s24, s24, 262144
    s_addc_u32 s25, s25, 0
    global_load_dwordx4 v[64:67], v8, s[24:25] sc0 sc1
    s_add_u32 s24, s24, 262144
    s_addc_u32 s25, s25, 0
    global_load_dwordx4 v[68:71], v8, s[24:25] sc0 sc1
    s_add_u32 s24, s24, 262144
    s_addc_u32 s25, s25, 0
    global_load_dwordx4 v[72:75], v8, s[24:25] sc0 sc1
    s_add_u32 s24, s24, 262144
    s_addc_u32 s25, s25, 0
    global_load_dwordx4 v[76:79], v8, s[24:25] sc0 sc1
    s_waitcnt vmcnt(0)
    v_xor_b32 v4, s34, v49
    v_xor_b32 v5, s34, v51
    v_or_b32 v4, v4, v5
    v_xor_b32 v5, s34, v53
    v_or_b32 v4, v4, v5
    v_xor_b32 v5, s34, v55
    v_or_b32 v4, v4, v5
    v_xor_b32 v5, s34, v57
    v_or_b32 v4, v4, v5
    v_xor_b32 v5, s34, v59
    v_or_b32 v4, v4, v5
    v_xor_b32 v5, s34, v61
    v_or_b32 v4, v4, v5
    v_xor_b32 v5, s34, v63
    v_or_b32 v4, v4, v5
    v_xor_b32 v5, s34, v65
    v_or_b32 v4, v4, v5
    v_xor_b32 v5, s34, v67
    v_or_b32 v4, v4, v5
    v_xor_b32 v5, s34, v69
    v_or_b32 v4, v4, v5
    v_xor_b32 v5, s34, v71
    v_or_b32 v4, v4, v5
    v_xor_b32 v5, s34, v73
    v_or_b32 v4, v4, v5
    v_xor_b32 v5, s34, v75
    v_or_b32 v4, v4, v5
    v_xor_b32 v5, s34, v77
    v_or_b32 v4, v4, v5
    v_xor_b32 v5, s34, v79
    v_or_b32 v4, v4, v5
    v_cmp_ne_u32 vcc, 0, v4
    s_cbranch_vccz L_E4_OK
    s_sub_u32 s35, s35, 1
    s_cbranch_scc1 L_EXIT
    s_sleep 1

    s_branch L_E4_POLL
L_E4_OK:
    v_add_f32 v48, v48, v52
    v_add_f32 v50, v50, v54
    v_add_f32 v48, v48, v56
    v_add_f32 v50, v50, v58
    v_add_f32 v48, v48, v60
    v_add_f32 v50, v50, v62
    v_add_f32 v48, v48, v64
    v_add_f32 v50, v50, v66
    v_add_f32 v48, v48, v68
    v_add_f32 v50, v50, v70
    v_add_f32 v48, v48, v72
    v_add_f32 v50, v50, v74
    v_add_f32 v48, v48, v76
    v_add_f32 v50, v50, v78
    v_mov_b32 v49, v50
    v_lshlrev_b32 v9, 6, v6
    v_lshl_add_u32 v9, v7, 3, v9
    v_add_u32 v9, 147456, v9
    ds_write_b64 v9, v[48:49]
    s_waitcnt lgkmcnt(0)
    s_barrier
    v_cmp_gt_u32 vcc, 16, v0
    s_and_saveexec_b64 s[22:23], vcc
    s_cbranch_execz L_END2
    v_lshlrev_b32 v9, 2, v0
    v_add_u32 v9, 147456, v9
    ds_read_b32 v48, v9 offset:0
    ds_read_b32 v49, v9 offset:64
    ds_read_b32 v50, v9 offset:128
    ds_read_b32 v51, v9 offset:192
    ds_read_b32 v52, v9 offset:256
    ds_read_b32 v53, v9 offset:320
    ds_read_b32 v54, v9 offset:384
    ds_read_b32 v55, v9 offset:448
    ds_read_b32 v56, v9 offset:512
    ds_read_b32 v57, v9 offset:576
    ds_read_b32 v58, v9 offset:640
    ds_read_b32 v59, v9 offset:704
    ds_read_b32 v60, v9 offset:768
    ds_read_b32 v61, v9 offset:832
    ds_read_b32 v62, v9 offset:896
    ds_read_b32 v63, v9 offset:960
    ds_read_b32 v64, v9 offset:1024
    ds_read_b32 v65, v9 offset:1088
    ds_read_b32 v66, v9 offset:1152
    ds_read_b32 v67, v9 offset:1216
    ds_read_b32 v68, v9 offset:1280
    ds_read_b32 v69, v9 offset:1344
    ds_read_b32 v70, v9 offset:1408
    ds_read_b32 v71, v9 offset:1472
    ds_read_b32 v72, v9 offset:1536
    ds_read_b32 v73, v9 offset:1600
    ds_read_b32 v74, v9 offset:1664
    ds_read_b32 v75, v9 offset:1728
    ds_read_b32 v76, v9 offset:1792
    ds_read_b32 v77, v9 offset:1856
    ds_read_b32 v78, v9 offset:1920
    ds_read_b32 v79, v9 offset:1984
    s_waitcnt lgkmcnt(0)
    v_add_f32 v48, v48, v49
    v_add_f32 v48, v48, v50
    v_add_f32 v48, v48, v51
    v_add_f32 v48, v48, v52
    v_add_f32 v48, v48, v53
    v_add_f32 v48, v48, v54
    v_add_f32 v48, v48, v55
    v_add_f32 v48, v48, v56
    v_add_f32 v48, v48, v57
    v_add_f32 v48, v48, v58
    v_add_f32 v48, v48, v59
    v_add_f32 v48, v48, v60
    v_add_f32 v48, v48, v61
    v_add_f32 v48, v48, v62
    v_add_f32 v48, v48, v63
    v_add_f32 v48, v48, v64
    v_add_f32 v48, v48, v65
    v_add_f32 v48, v48, v66
    v_add_f32 v48, v48, v67
    v_add_f32 v48, v48, v68
    v_add_f32 v48, v48, v69
    v_add_f32 v48, v48, v70
    v_add_f32 v48, v48, v71
    v_add_f32 v48, v48, v72
    v_add_f32 v48, v48, v73
    v_add_f32 v48, v48, v74
    v_add_f32 v48, v48, v75
    v_add_f32 v48, v48, v76
    v_add_f32 v48, v48, v77
    v_add_f32 v48, v48, v78
    v_add_f32 v48, v48, v79
    v_cvt_pk_bf16_f32 v48, v48, v48
    s_lshl_b32 s21, s2, 5
    v_lshlrev_b32 v9, 1, v0
    v_add_u32 v9, s21, v9
    global_store_short v9, v48, s[44:45]
L_END2:
    s_mov_b64 exec, s[22:23]
L_END:
    s_waitcnt vmcnt(0)
L_EXIT:
    s_endpgm
.section .rodata,"a"
.p2align 6
.amdhsa_kernel gated_mix__compressed_kv_cla__geglu_ffn__decode_kernel
  .amdhsa_next_free_vgpr 320
  .amdhsa_next_free_sgpr 100
  .amdhsa_accum_offset 256
  .amdhsa_group_segment_fixed_size 0
  .amdhsa_kernarg_size 112
  .amdhsa_user_sgpr_count 2
  .amdhsa_user_sgpr_kernarg_segment_ptr 1
  .amdhsa_system_sgpr_workgroup_id_x 1
.end_amdhsa_kernel
.text
```
